```python
import torch

def _softmax(x, axis=-1):
    return torch.softmax(x, dim=axis)

def _gelu(x):
    return torch.nn.functional.gelu(x, approximate='tanh')

def _silu(x):
    return torch.nn.functional.silu(x)

def _sigmoid(x):
    return torch.sigmoid(x)

def _layernorm(x, axis=-1, eps=1e-05):
    m = x.mean(dim=axis, keepdim=True)
    v = x.var(dim=axis, keepdim=True, unbiased=False)
    return (x - m) / torch.sqrt(v + eps)

def _scatter_add(tgt, idx, src, axis=0):
    return tgt.clone().index_add_(axis, idx, src)

def _segment_sum(src, seg, n):
    out = torch.zeros((n,) + src.shape[1:], dtype=src.dtype)
    return out.index_add_(0, seg, src)

def _pad(x, pw):
    flat = tuple((v for pair in reversed(pw) for v in pair))
    return torch.nn.functional.pad(x, flat)
kernel_name = 'standalone__dit_block__diffusion'

def setup_inputs():

    _w = lambda a: (lambda t: t.to(torch.bfloat16) if t.is_floating_point() else t)(torch.as_tensor(a))
    B, N, D = (2, 1024, 384)
    F = 4 * D
    return {'x': _w((lambda *s: torch.randn(*s, dtype=torch.bfloat16) * 0.05)(B, N, D)), 'c': _w((lambda *s: torch.randn(*s, dtype=torch.bfloat16) * 0.2)(B, D)), 'wqkv': _w((lambda *s: torch.randn(*s, dtype=torch.bfloat16) * 0.05)(D, 3 * D)), 'wo': _w((lambda *s: torch.randn(*s, dtype=torch.bfloat16) * 0.05)(D, D)), 'w_mod': _w((lambda *s: torch.randn(*s, dtype=torch.bfloat16) * 0.2)(D, 6 * D)), 'w_fc1': _w((lambda *s: torch.randn(*s, dtype=torch.bfloat16) * 0.05)(D, F)), 'w_fc2': _w((lambda *s: torch.randn(*s, dtype=torch.bfloat16) * 0.05)(F, D))}

def reference(x, c, wqkv, wo, w_mod, w_fc1, w_fc2):
    B, N, D = x.shape
    H = 2
    Dh = D // H
    mod = (_silu(c) @ w_mod).reshape(B, 6, 1, D)
    shift_a, scale_a, gate_a, shift_m, scale_m, gate_m = [mod[:, i] for i in range(6)]
    h = _layernorm(x, axis=-1) * (1 + scale_a) + shift_a
    qkv = (h @ wqkv).reshape(B, N, 3, H, Dh)
    q, k, v = (qkv[:, :, 0].clone(), qkv[:, :, 1].clone(), qkv[:, :, 2].clone())
    attn = _softmax(torch.einsum('bqhd,bkhd->bhqk', q, k) * Dh ** (-0.5), axis=-1)
    a = torch.einsum('bhqk,bkhd->bqhd', attn, v).reshape(B, N, D) @ wo
    x = x + gate_a * a
    h2 = _layernorm(x, axis=-1) * (1 + scale_m) + shift_m
    m = _gelu(h2 @ w_fc1) @ w_fc2
    return x + gate_m * m
```

```asm
; @launch grid=(256,1,1) block=(512,1,1) lds=163840
.amdgcn_target "amdgcn-amd-amdhsa--gfx950"
.text
.globl standalone__dit_block__diffusion_kernel
.p2align 8
.type standalone__dit_block__diffusion_kernel,@function
standalone__dit_block__diffusion_kernel:
    s_cmp_ge_u32 s2, 256
    s_cbranch_scc1 L_standalone__dit_block__diffusion_kernel_end
    s_load_dwordx2 s[8:9], s[0:1], 72
    s_load_dwordx2 s[12:13], s[0:1], 0
    s_load_dwordx2 s[16:17], s[0:1], 40
    s_load_dwordx2 s[20:21], s[0:1], 24
    s_load_dwordx2 s[24:25], s[0:1], 16
    s_load_dwordx2 s[28:29], s[0:1], 8
    s_load_dwordx2 s[32:33], s[0:1], 32
    s_load_dwordx2 s[44:45], s[0:1], 56
    s_load_dwordx2 s[96:97], s[0:1], 64
    s_mov_b32 s10, 0x1a80000
    s_mov_b32 s11, 0x20000
    s_mov_b32 s14, 0x180000
    s_mov_b32 s15, 0x20000
    s_mov_b32 s18, 0x120000
    s_mov_b32 s19, 0x20000
    s_mov_b32 s22, 0x48000
    s_mov_b32 s23, 0x20000
    s_mov_b32 s26, 0xd8000
    s_mov_b32 s27, 0x20000
    s_mov_b32 s30, 0x600
    s_mov_b32 s31, 0x20000
    s_mov_b32 s34, 0x1b0000
    s_mov_b32 s35, 0x20000
    s_mov_b32 s46, 0x180000
    s_mov_b32 s47, 0x20000
    s_mov_b32 s98, 0x100
    s_mov_b32 s99, 0x20000
    v_lshrrev_b32 v1, 6, v0
    v_and_b32 v2, 15, v0
    v_readfirstlane_b32 s3, v1
    v_bfe_u32 v3, v0, 4, 2
    v_and_b32 v4, 63, v0
    v_lshlrev_b32 v4, 4, v4
    s_and_b32 s4, s2, 7
    s_lshr_b32 s5, s2, 3
    s_lshl_b32 s48, s4, 3
    s_and_b32 s6, s5, 7
    s_add_u32 s48, s48, s6
    s_lshr_b32 s49, s5, 3
    s_mul_i32 s50, s49, 6
    s_add_u32 s50, s50, s3
    s_waitcnt lgkmcnt(0)
    s_cmp_lt_u32 s2, 36
    s_cbranch_scc1 L_standalone__dit_block__diffusion_kernel_mod
    s_cmp_lt_u32 s3, 7
    s_cbranch_scc1 L_standalone__dit_block__diffusion_kernel_nt
    v_lshlrev_b32 v7, 15, v4
    buffer_load_dword v198, v7, s[96:99], 0 offen sc1
    buffer_load_dword v197, v7, s[8:11], 0 offen sc1
    buffer_load_dword v196, v7, s[44:47], 0 offen sc1
L_standalone__dit_block__diffusion_kernel_nt:
    s_cmp_ge_u32 s2, 64
    s_cbranch_scc1 L_standalone__dit_block__diffusion_kernel_gemm
    s_cmp_lt_u32 s2, 36
    s_cbranch_scc1 L_standalone__dit_block__diffusion_kernel_mod
    s_getpc_b64 s[52:53]
L_standalone__dit_block__diffusion_kernel_pc:
    s_mov_b32 s54, L_standalone__dit_block__diffusion_kernel_end-L_standalone__dit_block__diffusion_kernel_pc
    s_mov_b32 s55, 0x20000
    s_lshl_b32 s6, s3, 13
    v_lshlrev_b32 v7, 3, v4
    buffer_load_dword v199, v7, s[52:55], s6 offen
    s_cmp_ge_u32 s2, 60
    s_cbranch_scc1 L_standalone__dit_block__diffusion_kernel_idle
    s_branch L_standalone__dit_block__diffusion_kernel_fc1
L_standalone__dit_block__diffusion_kernel_mod:
    v_and_b32 v8, 7, v0
    v_lshrrev_b32 v9, 3, v0
    v_mul_u32_u24 v10, 27648, v9
    v_lshl_add_u32 v10, v8, 4, v10
    v_mul_u32_u24 v11, 12, v9
    s_lshl_b32 s7, s2, 7
    buffer_load_dwordx3 v[80:82], v11, s[28:31], 0 offen offset:0
    buffer_load_dwordx3 v[84:86], v11, s[28:31], 0 offen offset:768
    buffer_load_dwordx4 v[16:19], v10, s[32:35], s7 offen
    s_add_u32 s7, s7, 4608
    buffer_load_dwordx4 v[20:23], v10, s[32:35], s7 offen
    s_add_u32 s7, s7, 4608
    buffer_load_dwordx4 v[24:27], v10, s[32:35], s7 offen
    s_add_u32 s7, s7, 4608
    buffer_load_dwordx4 v[28:31], v10, s[32:35], s7 offen
    s_add_u32 s7, s7, 4608
    buffer_load_dwordx4 v[32:35], v10, s[32:35], s7 offen
    s_add_u32 s7, s7, 4608
    buffer_load_dwordx4 v[36:39], v10, s[32:35], s7 offen
    s_waitcnt vmcnt(6)
    v_lshlrev_b32 v40, 16, v80
    v_and_b32 v41, 0xffff0000, v80
    v_lshlrev_b32 v42, 16, v81
    v_and_b32 v43, 0xffff0000, v81
    v_lshlrev_b32 v44, 16, v82
    v_and_b32 v45, 0xffff0000, v82
    v_lshlrev_b32 v46, 16, v84
    v_and_b32 v47, 0xffff0000, v84
    v_lshlrev_b32 v48, 16, v85
    v_and_b32 v49, 0xffff0000, v85
    v_lshlrev_b32 v50, 16, v86
    v_and_b32 v51, 0xffff0000, v86
    v_mul_f32 v52, 0xbfb8aa3b, v40
    v_exp_f32 v52, v52
    v_mul_f32 v53, 0xbfb8aa3b, v41
    v_exp_f32 v53, v53
    v_mul_f32 v54, 0xbfb8aa3b, v42
    v_exp_f32 v54, v54
    v_mul_f32 v55, 0xbfb8aa3b, v43
    v_exp_f32 v55, v55
    v_mul_f32 v56, 0xbfb8aa3b, v44
    v_exp_f32 v56, v56
    v_mul_f32 v57, 0xbfb8aa3b, v45
    v_exp_f32 v57, v57
    v_mul_f32 v58, 0xbfb8aa3b, v46
    v_exp_f32 v58, v58
    v_mul_f32 v59, 0xbfb8aa3b, v47
    v_exp_f32 v59, v59
    v_mul_f32 v60, 0xbfb8aa3b, v48
    v_exp_f32 v60, v60
    v_mul_f32 v61, 0xbfb8aa3b, v49
    v_exp_f32 v61, v61
    v_mul_f32 v62, 0xbfb8aa3b, v50
    v_exp_f32 v62, v62
    v_mul_f32 v63, 0xbfb8aa3b, v51
    v_exp_f32 v63, v63
    v_add_f32 v52, 1.0, v52
    v_rcp_f32 v52, v52
    v_add_f32 v53, 1.0, v53
    v_rcp_f32 v53, v53
    v_add_f32 v54, 1.0, v54
    v_rcp_f32 v54, v54
    v_add_f32 v55, 1.0, v55
    v_rcp_f32 v55, v55
    v_add_f32 v56, 1.0, v56
    v_rcp_f32 v56, v56
    v_add_f32 v57, 1.0, v57
    v_rcp_f32 v57, v57
    v_add_f32 v58, 1.0, v58
    v_rcp_f32 v58, v58
    v_add_f32 v59, 1.0, v59
    v_rcp_f32 v59, v59
    v_add_f32 v60, 1.0, v60
    v_rcp_f32 v60, v60
    v_add_f32 v61, 1.0, v61
    v_rcp_f32 v61, v61
    v_add_f32 v62, 1.0, v62
    v_rcp_f32 v62, v62
    v_add_f32 v63, 1.0, v63
    v_rcp_f32 v63, v63
    v_mul_f32 v40, v40, v52
    v_cvt_pk_bf16_f32 v40, v40, v40
    v_lshlrev_b32 v40, 16, v40
    v_mul_f32 v41, v41, v53
    v_cvt_pk_bf16_f32 v41, v41, v41
    v_lshlrev_b32 v41, 16, v41
    v_mul_f32 v42, v42, v54
    v_cvt_pk_bf16_f32 v42, v42, v42
    v_lshlrev_b32 v42, 16, v42
    v_mul_f32 v43, v43, v55
    v_cvt_pk_bf16_f32 v43, v43, v43
    v_lshlrev_b32 v43, 16, v43
    v_mul_f32 v44, v44, v56
    v_cvt_pk_bf16_f32 v44, v44, v44
    v_lshlrev_b32 v44, 16, v44
    v_mul_f32 v45, v45, v57
    v_cvt_pk_bf16_f32 v45, v45, v45
    v_lshlrev_b32 v45, 16, v45
    v_mul_f32 v46, v46, v58
    v_cvt_pk_bf16_f32 v46, v46, v46
    v_lshlrev_b32 v46, 16, v46
    v_mul_f32 v47, v47, v59
    v_cvt_pk_bf16_f32 v47, v47, v47
    v_lshlrev_b32 v47, 16, v47
    v_mul_f32 v48, v48, v60
    v_cvt_pk_bf16_f32 v48, v48, v48
    v_lshlrev_b32 v48, 16, v48
    v_mul_f32 v49, v49, v61
    v_cvt_pk_bf16_f32 v49, v49, v49
    v_lshlrev_b32 v49, 16, v49
    v_mul_f32 v50, v50, v62
    v_cvt_pk_bf16_f32 v50, v50, v50
    v_lshlrev_b32 v50, 16, v50
    v_mul_f32 v51, v51, v63
    v_cvt_pk_bf16_f32 v51, v51, v51
    v_lshlrev_b32 v51, 16, v51
    s_waitcnt vmcnt(5)
    v_lshlrev_b32 v5, 16, v16
    v_and_b32 v6, 0xffff0000, v16
    v_mul_f32 v64, v5, v40
    v_mul_f32 v65, v6, v40
    v_mul_f32 v72, v5, v46
    v_mul_f32 v73, v6, v46
    v_lshlrev_b32 v5, 16, v17
    v_and_b32 v6, 0xffff0000, v17
    v_mul_f32 v66, v5, v40
    v_mul_f32 v67, v6, v40
    v_mul_f32 v74, v5, v46
    v_mul_f32 v75, v6, v46
    v_lshlrev_b32 v5, 16, v18
    v_and_b32 v6, 0xffff0000, v18
    v_mul_f32 v68, v5, v40
    v_mul_f32 v69, v6, v40
    v_mul_f32 v76, v5, v46
    v_mul_f32 v77, v6, v46
    v_lshlrev_b32 v5, 16, v19
    v_and_b32 v6, 0xffff0000, v19
    v_mul_f32 v70, v5, v40
    v_mul_f32 v71, v6, v40
    v_mul_f32 v78, v5, v46
    v_mul_f32 v79, v6, v46
    s_waitcnt vmcnt(4)
    v_lshlrev_b32 v5, 16, v20
    v_and_b32 v6, 0xffff0000, v20
    v_fmac_f32 v64, v5, v41
    v_fmac_f32 v65, v6, v41
    v_fmac_f32 v72, v5, v47
    v_fmac_f32 v73, v6, v47
    v_lshlrev_b32 v5, 16, v21
    v_and_b32 v6, 0xffff0000, v21
    v_fmac_f32 v66, v5, v41
    v_fmac_f32 v67, v6, v41
    v_fmac_f32 v74, v5, v47
    v_fmac_f32 v75, v6, v47
    v_lshlrev_b32 v5, 16, v22
    v_and_b32 v6, 0xffff0000, v22
    v_fmac_f32 v68, v5, v41
    v_fmac_f32 v69, v6, v41
    v_fmac_f32 v76, v5, v47
    v_fmac_f32 v77, v6, v47
    v_lshlrev_b32 v5, 16, v23
    v_and_b32 v6, 0xffff0000, v23
    v_fmac_f32 v70, v5, v41
    v_fmac_f32 v71, v6, v41
    v_fmac_f32 v78, v5, v47
    v_fmac_f32 v79, v6, v47
    s_waitcnt vmcnt(3)
    v_lshlrev_b32 v5, 16, v24
    v_and_b32 v6, 0xffff0000, v24
    v_fmac_f32 v64, v5, v42
    v_fmac_f32 v65, v6, v42
    v_fmac_f32 v72, v5, v48
    v_fmac_f32 v73, v6, v48
    v_lshlrev_b32 v5, 16, v25
    v_and_b32 v6, 0xffff0000, v25
    v_fmac_f32 v66, v5, v42
    v_fmac_f32 v67, v6, v42
    v_fmac_f32 v74, v5, v48
    v_fmac_f32 v75, v6, v48
    v_lshlrev_b32 v5, 16, v26
    v_and_b32 v6, 0xffff0000, v26
    v_fmac_f32 v68, v5, v42
    v_fmac_f32 v69, v6, v42
    v_fmac_f32 v76, v5, v48
    v_fmac_f32 v77, v6, v48
    v_lshlrev_b32 v5, 16, v27
    v_and_b32 v6, 0xffff0000, v27
    v_fmac_f32 v70, v5, v42
    v_fmac_f32 v71, v6, v42
    v_fmac_f32 v78, v5, v48
    v_fmac_f32 v79, v6, v48
    s_waitcnt vmcnt(2)
    v_lshlrev_b32 v5, 16, v28
    v_and_b32 v6, 0xffff0000, v28
    v_fmac_f32 v64, v5, v43
    v_fmac_f32 v65, v6, v43
    v_fmac_f32 v72, v5, v49
    v_fmac_f32 v73, v6, v49
    v_lshlrev_b32 v5, 16, v29
    v_and_b32 v6, 0xffff0000, v29
    v_fmac_f32 v66, v5, v43
    v_fmac_f32 v67, v6, v43
    v_fmac_f32 v74, v5, v49
    v_fmac_f32 v75, v6, v49
    v_lshlrev_b32 v5, 16, v30
    v_and_b32 v6, 0xffff0000, v30
    v_fmac_f32 v68, v5, v43
    v_fmac_f32 v69, v6, v43
    v_fmac_f32 v76, v5, v49
    v_fmac_f32 v77, v6, v49
    v_lshlrev_b32 v5, 16, v31
    v_and_b32 v6, 0xffff0000, v31
    v_fmac_f32 v70, v5, v43
    v_fmac_f32 v71, v6, v43
    v_fmac_f32 v78, v5, v49
    v_fmac_f32 v79, v6, v49
    s_waitcnt vmcnt(1)
    v_lshlrev_b32 v5, 16, v32
    v_and_b32 v6, 0xffff0000, v32
    v_fmac_f32 v64, v5, v44
    v_fmac_f32 v65, v6, v44
    v_fmac_f32 v72, v5, v50
    v_fmac_f32 v73, v6, v50
    v_lshlrev_b32 v5, 16, v33
    v_and_b32 v6, 0xffff0000, v33
    v_fmac_f32 v66, v5, v44
    v_fmac_f32 v67, v6, v44
    v_fmac_f32 v74, v5, v50
    v_fmac_f32 v75, v6, v50
    v_lshlrev_b32 v5, 16, v34
    v_and_b32 v6, 0xffff0000, v34
    v_fmac_f32 v68, v5, v44
    v_fmac_f32 v69, v6, v44
    v_fmac_f32 v76, v5, v50
    v_fmac_f32 v77, v6, v50
    v_lshlrev_b32 v5, 16, v35
    v_and_b32 v6, 0xffff0000, v35
    v_fmac_f32 v70, v5, v44
    v_fmac_f32 v71, v6, v44
    v_fmac_f32 v78, v5, v50
    v_fmac_f32 v79, v6, v50
    s_waitcnt vmcnt(0)
    v_lshlrev_b32 v5, 16, v36
    v_and_b32 v6, 0xffff0000, v36
    v_fmac_f32 v64, v5, v45
    v_fmac_f32 v65, v6, v45
    v_fmac_f32 v72, v5, v51
    v_fmac_f32 v73, v6, v51
    v_lshlrev_b32 v5, 16, v37
    v_and_b32 v6, 0xffff0000, v37
    v_fmac_f32 v66, v5, v45
    v_fmac_f32 v67, v6, v45
    v_fmac_f32 v74, v5, v51
    v_fmac_f32 v75, v6, v51
    v_lshlrev_b32 v5, 16, v38
    v_and_b32 v6, 0xffff0000, v38
    v_fmac_f32 v68, v5, v45
    v_fmac_f32 v69, v6, v45
    v_fmac_f32 v76, v5, v51
    v_fmac_f32 v77, v6, v51
    v_lshlrev_b32 v5, 16, v39
    v_and_b32 v6, 0xffff0000, v39
    v_fmac_f32 v70, v5, v45
    v_fmac_f32 v71, v6, v45
    v_fmac_f32 v78, v5, v51
    v_fmac_f32 v79, v6, v51
    s_cmp_ge_u32 s2, 12
    s_cbranch_scc1 L_standalone__dit_block__diffusion_kernel_nz
    v_mov_b32 v12, 0
    v_mov_b32 v13, 0
    v_mov_b32 v14, 0
    v_mov_b32 v15, 0
    v_lshlrev_b32 v5, 4, v0
    s_lshl_b32 s6, s2, 14
    s_add_u32 s6, s6, 0x40000
    buffer_store_dwordx4 v[12:15], v5, s[8:11], s6 offen sc1
    s_add_u32 s6, s6, 8192
    buffer_store_dwordx4 v[12:15], v5, s[8:11], s6 offen sc1
L_standalone__dit_block__diffusion_kernel_nz:
    s_nop 1
    v_add_f32_dpp v64, v64, v64 row_ror:8 row_mask:0xf bank_mask:0xf
    v_add_f32_dpp v65, v65, v65 row_ror:8 row_mask:0xf bank_mask:0xf
    v_add_f32_dpp v66, v66, v66 row_ror:8 row_mask:0xf bank_mask:0xf
    v_add_f32_dpp v67, v67, v67 row_ror:8 row_mask:0xf bank_mask:0xf
    v_add_f32_dpp v68, v68, v68 row_ror:8 row_mask:0xf bank_mask:0xf
    v_add_f32_dpp v69, v69, v69 row_ror:8 row_mask:0xf bank_mask:0xf
    v_add_f32_dpp v70, v70, v70 row_ror:8 row_mask:0xf bank_mask:0xf
    v_add_f32_dpp v71, v71, v71 row_ror:8 row_mask:0xf bank_mask:0xf
    v_add_f32_dpp v72, v72, v72 row_ror:8 row_mask:0xf bank_mask:0xf
    v_add_f32_dpp v73, v73, v73 row_ror:8 row_mask:0xf bank_mask:0xf
    v_add_f32_dpp v74, v74, v74 row_ror:8 row_mask:0xf bank_mask:0xf
    v_add_f32_dpp v75, v75, v75 row_ror:8 row_mask:0xf bank_mask:0xf
    v_add_f32_dpp v76, v76, v76 row_ror:8 row_mask:0xf bank_mask:0xf
    v_add_f32_dpp v77, v77, v77 row_ror:8 row_mask:0xf bank_mask:0xf
    v_add_f32_dpp v78, v78, v78 row_ror:8 row_mask:0xf bank_mask:0xf
    v_add_f32_dpp v79, v79, v79 row_ror:8 row_mask:0xf bank_mask:0xf
    s_nop 1
    v_permlane32_swap_b32 v64, v72
    v_permlane32_swap_b32 v65, v73
    v_permlane32_swap_b32 v66, v74
    v_permlane32_swap_b32 v67, v75
    v_permlane32_swap_b32 v68, v76
    v_permlane32_swap_b32 v69, v77
    v_permlane32_swap_b32 v70, v78
    v_permlane32_swap_b32 v71, v79
    v_add_f32 v64, v64, v72
    v_add_f32 v65, v65, v73
    v_add_f32 v66, v66, v74
    v_add_f32 v67, v67, v75
    v_add_f32 v68, v68, v76
    v_add_f32 v69, v69, v77
    v_add_f32 v70, v70, v78
    v_add_f32 v71, v71, v79
    s_nop 1
    v_permlane16_swap_b32 v64, v68
    v_permlane16_swap_b32 v65, v69
    v_permlane16_swap_b32 v66, v70
    v_permlane16_swap_b32 v67, v71
    v_lshlrev_b32 v5, 9, v1
    v_lshl_add_u32 v5, v8, 6, v5
    v_lshl_add_u32 v5, v3, 4, v5
    v_add_f32 v64, v64, v68
    v_add_f32 v65, v65, v69
    v_add_f32 v66, v66, v70
    v_add_f32 v67, v67, v71
    ds_write_b128 v5, v[64:67]
    s_waitcnt lgkmcnt(0)
    s_barrier
    s_cmp_ge_u32 s3, 2
    s_cbranch_scc1 L_standalone__dit_block__diffusion_kernel_m2
    v_lshlrev_b32 v5, 2, v0
    ds_read_b32 v16, v5 offset:0
    ds_read_b32 v17, v5 offset:512
    ds_read_b32 v18, v5 offset:1024
    ds_read_b32 v19, v5 offset:1536
    ds_read_b32 v20, v5 offset:2048
    ds_read_b32 v21, v5 offset:2560
    ds_read_b32 v22, v5 offset:3072
    ds_read_b32 v23, v5 offset:3584
    s_waitcnt lgkmcnt(0)
    v_add_f32 v16, v16, v20
    v_add_f32 v17, v17, v21
    v_add_f32 v18, v18, v22
    v_add_f32 v19, v19, v23
    v_add_f32 v16, v16, v18
    v_add_f32 v17, v17, v19
    v_add_f32 v16, v16, v17
    v_cvt_pk_bf16_f32 v8, v16, v16
    v_lshlrev_b32 v8, 16, v8
    s_sub_u32 s7, s2, 6
    s_cmp_lt_u32 s7, 6
    s_cselect_b32 s6, 1.0, 0
    s_sub_u32 s7, s2, 24
    s_cmp_lt_u32 s7, 6
    s_cselect_b32 s6, 1.0, s6
    v_add_f32 v8, s6, v8
    v_cvt_pk_bf16_f32 v8, v8, v8
    v_lshlrev_b32 v8, 16, v8
    v_lshrrev_b32 v5, 4, v0
    v_lshlrev_b32 v5, 5, v5
    v_and_b32 v6, 7, v0
    v_lshl_add_u32 v5, v6, 2, v5
    v_bfe_u32 v6, v0, 3, 1
    v_mul_u32_u24 v6, 9216, v6
    v_add_u32 v5, v5, v6
    s_lshl_b32 s6, s2, 8
    buffer_store_dword v8, v5, s[8:11], s6 offen sc1
L_standalone__dit_block__diffusion_kernel_m2:
    s_waitcnt vmcnt(0)
    s_barrier
    s_cmp_lg_u32 s3, 0
    s_cbranch_scc1 L_standalone__dit_block__diffusion_kernel_m3
    s_cmp_lt_u32 s2, 12
    s_cselect_b32 s6, 0, 4
    s_sub_u32 s7, s2, 12
    s_cmp_lt_u32 s7, 6
    s_cbranch_scc1 L_standalone__dit_block__diffusion_kernel_m3
    s_cmp_ge_u32 s2, 30
    s_cbranch_scc1 L_standalone__dit_block__diffusion_kernel_m3
    v_mov_b32 v5, 0
    v_mov_b32 v6, 1
    s_mov_b64 exec, 1
    buffer_atomic_add v6, v5, s[96:99], s6 offen offset:128 sc0 sc1
    s_waitcnt vmcnt(0)
    v_readfirstlane_b32 s7, v6
    s_nop 3
    s_cmp_lg_u32 s7, 11
    s_cbranch_scc1 L_standalone__dit_block__diffusion_kernel_m4
    buffer_store_dword v6, v5, s[96:99], s6 offen sc1
L_standalone__dit_block__diffusion_kernel_m4:
    s_mov_b64 exec, -1
L_standalone__dit_block__diffusion_kernel_m3:
L_standalone__dit_block__diffusion_kernel_idle:
    s_cmp_lg_u32 s3, 7
    s_cbranch_scc1 L_standalone__dit_block__diffusion_kernel_pdi
    v_mov_b32 v5, 0
    s_mov_b32 s7, 0
L_standalone__dit_block__diffusion_kernel_pli:
    buffer_load_dword v6, v5, s[96:99], 0 offen sc1
    s_waitcnt vmcnt(0)
    v_cmp_eq_u32 vcc, 0, v6
    s_add_u32 s7, s7, 1
    s_cmp_ge_u32 s7, 0x10000
    s_cbranch_scc1 L_standalone__dit_block__diffusion_kernel_pdi
    s_nop 2
    s_cbranch_vccz L_standalone__dit_block__diffusion_kernel_pdi
    s_sleep 16
    s_branch L_standalone__dit_block__diffusion_kernel_pli
L_standalone__dit_block__diffusion_kernel_pdi:
    s_barrier
    s_cmp_ge_u32 s2, 36
    s_cbranch_scc1 L_standalone__dit_block__diffusion_kernel_i2
    s_lshl_b32 s35, s2, 2
    s_add_u32 s35, s35, 1120
    s_load_dwordx2 s[16:17], s[0:1], 48
    s_mul_hi_u32 s24, s2, 0x2aaaaaab
    s_mul_i32 s6, s24, 6
    s_sub_u32 s25, s2, s6
    s_lshl_b32 s24, s24, 3
    s_add_u32 s24, s24, s3
    s_mul_i32 s26, s24, 24576
    s_lshl_b32 s6, s25, 7
    s_add_u32 s26, s26, s6
    s_lshl_b32 s27, s3, 12
    s_add_u32 s27, s27, 8192
    v_lshrrev_b32 v5, 7, v4
    v_mul_u32_u24 v5, 768, v5
    v_and_b32 v6, 0x70, v4
    v_add_u32 v5, v5, v6
    v_lshrrev_b32 v7, 2, v2
    v_lshl_add_u32 v7, v3, 2, v7
    v_lshlrev_b32 v7, 7, v7
    v_and_b32 v6, 3, v2
    v_lshl_add_u32 v7, v6, 3, v7
    v_add_u32 v7, s27, v7
    s_waitcnt lgkmcnt(0)
    s_mov_b32 m0, s27
    s_add_u32 s27, s27, 1024
    buffer_load_dwordx4 v5, s[16:19], s26 offen lds
    s_add_u32 s26, s26, 6144
    s_mov_b32 m0, s27
    s_add_u32 s27, s27, 1024
    buffer_load_dwordx4 v5, s[16:19], s26 offen lds
    s_add_u32 s26, s26, 6144
    s_mov_b32 m0, s27
    s_add_u32 s27, s27, 1024
    buffer_load_dwordx4 v5, s[16:19], s26 offen lds
    s_add_u32 s26, s26, 6144
    s_mov_b32 m0, s27
    s_add_u32 s27, s27, 1024
    buffer_load_dwordx4 v5, s[16:19], s26 offen lds
    s_add_u32 s26, s26, 6144
    s_mul_i32 s26, s25, 196608
    s_lshl_b32 s6, s24, 10
    s_add_u32 s26, s26, s6
    s_add_u32 s26, s26, 0x180000
    s_waitcnt vmcnt(0)
    ds_read_b64_tr_b16 v[8:9], v7 offset:0
    ds_read_b64_tr_b16 v[10:11], v7 offset:2048
    ds_read_b64_tr_b16 v[12:13], v7 offset:32
    ds_read_b64_tr_b16 v[14:15], v7 offset:2080
    ds_read_b64_tr_b16 v[16:17], v7 offset:64
    ds_read_b64_tr_b16 v[18:19], v7 offset:2112
    ds_read_b64_tr_b16 v[20:21], v7 offset:96
    ds_read_b64_tr_b16 v[22:23], v7 offset:2144
    s_waitcnt lgkmcnt(0)
    buffer_store_dwordx4 v[8:11], v4, s[8:11], s26 offen sc1
    s_add_u32 s26, s26, 49152
    buffer_store_dwordx4 v[12:15], v4, s[8:11], s26 offen sc1
    s_add_u32 s26, s26, 49152
    buffer_store_dwordx4 v[16:19], v4, s[8:11], s26 offen sc1
    s_add_u32 s26, s26, 49152
    buffer_store_dwordx4 v[20:23], v4, s[8:11], s26 offen sc1
    s_add_u32 s26, s26, 49152
    s_waitcnt vmcnt(0)
    s_barrier
    s_cmp_lg_u32 s3, 0
    s_cbranch_scc1 L_standalone__dit_block__diffusion_kernel_sgm
    v_mov_b32 v5, 0
    v_mov_b32 v6, 1
    s_lshl_b32 s35, s35, 5
    s_add_u32 s35, s35, 0x40000
    s_mov_b64 exec, 1
    buffer_store_dword v6, v5, s[8:11], s35 offen sc1
    s_mov_b64 exec, -1
L_standalone__dit_block__diffusion_kernel_sgm:
L_standalone__dit_block__diffusion_kernel_i2:
    s_mov_b32 s6, 0x15555556
    s_mov_b32 s7, 768
    v_lshrrev_b32 v171, 4, v4
    v_add_u32 v171, 0, v171
    v_mul_hi_u32 v168, v171, s6
    v_mul_u32_u24 v172, 12, v168
    v_sub_u32 v171, v171, v172
    v_lshrrev_b32 v172, 2, v168
    v_and_b32 v172, 2, v172
    v_xor_b32 v171, v171, v172
    v_mul_lo_u32 v168, v168, s7
    v_lshl_add_u32 v168, v171, 4, v168
    v_lshrrev_b32 v171, 4, v4
    v_add_u32 v171, 64, v171
    v_mul_hi_u32 v169, v171, s6
    v_mul_u32_u24 v172, 12, v169
    v_sub_u32 v171, v171, v172
    v_lshrrev_b32 v172, 2, v169
    v_and_b32 v172, 2, v172
    v_xor_b32 v171, v171, v172
    v_mul_lo_u32 v169, v169, s7
    v_lshl_add_u32 v169, v171, 4, v169
    v_lshrrev_b32 v171, 4, v4
    v_add_u32 v171, 128, v171
    v_mul_hi_u32 v170, v171, s6
    v_mul_u32_u24 v172, 12, v170
    v_sub_u32 v171, v171, v172
    v_lshrrev_b32 v172, 2, v170
    v_and_b32 v172, 2, v172
    v_xor_b32 v171, v171, v172
    v_mul_lo_u32 v170, v170, s7
    v_lshl_add_u32 v170, v171, 4, v170
    s_mul_i32 s36, s3, 9216
    s_add_u32 s36, s36, 77824
    s_mul_i32 s37, s3, 36864
    s_mul_i32 s6, s49, 192
    s_add_u32 s37, s37, s6
    s_mov_b32 m0, s36
    s_add_u32 s36, s36, 1024
    buffer_load_dwordx4 v168, s[20:23], s37 offen lds
    s_mov_b32 m0, s36
    s_add_u32 s36, s36, 1024
    buffer_load_dwordx4 v169, s[20:23], s37 offen lds
    s_mov_b32 m0, s36
    s_add_u32 s36, s36, 1024
    buffer_load_dwordx4 v170, s[20:23], s37 offen lds
    s_add_u32 s37, s37, 12288
    s_mov_b32 m0, s36
    s_add_u32 s36, s36, 1024
    buffer_load_dwordx4 v168, s[20:23], s37 offen lds
    s_mov_b32 m0, s36
    s_add_u32 s36, s36, 1024
    buffer_load_dwordx4 v169, s[20:23], s37 offen lds
    s_mov_b32 m0, s36
    s_add_u32 s36, s36, 1024
    buffer_load_dwordx4 v170, s[20:23], s37 offen lds
    s_add_u32 s37, s37, 12288
    s_mov_b32 m0, s36
    s_add_u32 s36, s36, 1024
    buffer_load_dwordx4 v168, s[20:23], s37 offen lds
    s_mov_b32 m0, s36
    s_add_u32 s36, s36, 1024
    buffer_load_dwordx4 v169, s[20:23], s37 offen lds
    s_mov_b32 m0, s36
    s_add_u32 s36, s36, 1024
    buffer_load_dwordx4 v170, s[20:23], s37 offen lds
    s_add_u32 s37, s37, 12288
    s_waitcnt vmcnt(0)
    s_barrier
    s_branch L_standalone__dit_block__diffusion_kernel_p1x
L_standalone__dit_block__diffusion_kernel_fc1:
    s_sub_u32 s24, s2, 36
    v_lshrrev_b32 v5, 7, v4
    v_mul_u32_u24 v5, 3072, v5
    v_and_b32 v6, 0x70, v4
    v_add_u32 v5, v5, v6
    s_mul_i32 s25, s3, 6144
    s_mul_i32 s26, s3, 147456
    s_lshl_b32 s6, s24, 7
    s_add_u32 s26, s26, s6
    s_mov_b32 m0, s25
    s_add_u32 s25, s25, 1024
    buffer_load_dwordx4 v5, s[16:19], s26 offen lds
    s_add_u32 s26, s26, 24576
    s_mov_b32 m0, s25
    s_add_u32 s25, s25, 1024
    buffer_load_dwordx4 v5, s[16:19], s26 offen lds
    s_add_u32 s26, s26, 24576
    s_mov_b32 m0, s25
    s_add_u32 s25, s25, 1024
    buffer_load_dwordx4 v5, s[16:19], s26 offen lds
    s_add_u32 s26, s26, 24576
    s_mov_b32 m0, s25
    s_add_u32 s25, s25, 1024
    buffer_load_dwordx4 v5, s[16:19], s26 offen lds
    s_add_u32 s26, s26, 24576
    s_mov_b32 m0, s25
    s_add_u32 s25, s25, 1024
    buffer_load_dwordx4 v5, s[16:19], s26 offen lds
    s_add_u32 s26, s26, 24576
    s_mov_b32 m0, s25
    s_add_u32 s25, s25, 1024
    buffer_load_dwordx4 v5, s[16:19], s26 offen lds
    s_add_u32 s26, s26, 24576
    s_mov_b32 s6, 0x15555556
    s_mov_b32 s7, 768
    v_lshrrev_b32 v171, 4, v4
    v_add_u32 v171, 0, v171
    v_mul_hi_u32 v168, v171, s6
    v_mul_u32_u24 v172, 12, v168
    v_sub_u32 v171, v171, v172
    v_lshrrev_b32 v172, 2, v168
    v_and_b32 v172, 2, v172
    v_xor_b32 v171, v171, v172
    v_mul_lo_u32 v168, v168, s7
    v_lshl_add_u32 v168, v171, 4, v168
    v_lshrrev_b32 v171, 4, v4
    v_add_u32 v171, 64, v171
    v_mul_hi_u32 v169, v171, s6
    v_mul_u32_u24 v172, 12, v169
    v_sub_u32 v171, v171, v172
    v_lshrrev_b32 v172, 2, v169
    v_and_b32 v172, 2, v172
    v_xor_b32 v171, v171, v172
    v_mul_lo_u32 v169, v169, s7
    v_lshl_add_u32 v169, v171, 4, v169
    v_lshrrev_b32 v171, 4, v4
    v_add_u32 v171, 128, v171
    v_mul_hi_u32 v170, v171, s6
    v_mul_u32_u24 v172, 12, v170
    v_sub_u32 v171, v171, v172
    v_lshrrev_b32 v172, 2, v170
    v_and_b32 v172, 2, v172
    v_xor_b32 v171, v171, v172
    v_mul_lo_u32 v170, v170, s7
    v_lshl_add_u32 v170, v171, 4, v170
    s_mul_i32 s36, s3, 9216
    s_add_u32 s36, s36, 77824
    s_mul_i32 s37, s3, 36864
    s_mul_i32 s6, s49, 192
    s_add_u32 s37, s37, s6
    s_mov_b32 m0, s36
    s_add_u32 s36, s36, 1024
    buffer_load_dwordx4 v168, s[20:23], s37 offen lds
    s_mov_b32 m0, s36
    s_add_u32 s36, s36, 1024
    buffer_load_dwordx4 v169, s[20:23], s37 offen lds
    s_mov_b32 m0, s36
    s_add_u32 s36, s36, 1024
    buffer_load_dwordx4 v170, s[20:23], s37 offen lds
    s_add_u32 s37, s37, 12288
    s_mov_b32 m0, s36
    s_add_u32 s36, s36, 1024
    buffer_load_dwordx4 v168, s[20:23], s37 offen lds
    s_mov_b32 m0, s36
    s_add_u32 s36, s36, 1024
    buffer_load_dwordx4 v169, s[20:23], s37 offen lds
    s_mov_b32 m0, s36
    s_add_u32 s36, s36, 1024
    buffer_load_dwordx4 v170, s[20:23], s37 offen lds
    s_add_u32 s37, s37, 12288
    s_mov_b32 m0, s36
    s_add_u32 s36, s36, 1024
    buffer_load_dwordx4 v168, s[20:23], s37 offen lds
    s_mov_b32 m0, s36
    s_add_u32 s36, s36, 1024
    buffer_load_dwordx4 v169, s[20:23], s37 offen lds
    s_mov_b32 m0, s36
    s_add_u32 s36, s36, 1024
    buffer_load_dwordx4 v170, s[20:23], s37 offen lds
    s_add_u32 s37, s37, 12288
    s_lshr_b32 s27, s3, 1
    s_and_b32 s25, s3, 1
    v_lshrrev_b32 v7, 2, v2
    v_lshl_add_u32 v7, v3, 3, v7
    v_lshlrev_b32 v7, 7, v7
    v_and_b32 v6, 3, v2
    v_lshl_add_u32 v7, v6, 3, v7
    s_mul_i32 s6, s25, 24576
    s_lshl_b32 s7, s27, 5
    s_add_u32 s6, s6, s7
    v_add_u32 v7, s6, v7
    s_lshl_b32 s6, s24, 2
    s_add_u32 s27, s27, s6
    s_min_u32 s6, s3, 5
    s_lshl_b32 s37, s6, 10
    s_cmp_ge_u32 s6, 3
    s_cselect_b32 s26, 6144, 0
    s_add_u32 s26, s26, s37
    s_add_u32 s26, s26, 0x1200
    s_add_u32 s37, s37, 53248
    s_mul_i32 s36, s27, 12288
    s_mul_i32 s6, s25, 6144
    s_add_u32 s36, s36, s6
    s_add_u32 s36, s36, 0x300000
    s_mov_b32 s40, 0x3f803f80
    s_waitcnt vmcnt(0)
    v_mov_b32 v192, 0x3f803f80
    v_mov_b32 v193, 0x3f803f80
    v_mov_b32 v194, 0x3f803f80
    v_mov_b32 v195, 0x3f803f80
    s_cmp_lg_u32 s3, 7
    s_cbranch_scc1 L_standalone__dit_block__diffusion_kernel_pdf
    v_mov_b32 v5, 0
    v_and_b32 v6, 1, v3
    v_lshlrev_b32 v5, 2, v6
    s_mov_b32 s7, 0
L_standalone__dit_block__diffusion_kernel_plf:
    buffer_load_dword v6, v5, s[96:99], 0 offen sc1
    s_waitcnt vmcnt(0)
    v_cmp_eq_u32 vcc, 0, v6
    s_add_u32 s7, s7, 1
    s_cmp_ge_u32 s7, 0x10000
    s_cbranch_scc1 L_standalone__dit_block__diffusion_kernel_pdf
    s_nop 2
    s_cbranch_vccz L_standalone__dit_block__diffusion_kernel_pdf
    s_sleep 6
    s_branch L_standalone__dit_block__diffusion_kernel_plf
L_standalone__dit_block__diffusion_kernel_pdf:
    s_barrier
    s_mov_b32 m0, s37
    s_nop 0
    buffer_load_dwordx4 v4, s[8:11], s26 offen sc1 lds
    ds_read_b64_tr_b16 v[8:9], v7 offset:0
    ds_read_b64_tr_b16 v[10:11], v7 offset:512
    ds_read_b64_tr_b16 v[12:13], v7 offset:4096
    ds_read_b64_tr_b16 v[14:15], v7 offset:4608
    ds_read_b64_tr_b16 v[16:17], v7 offset:8192
    ds_read_b64_tr_b16 v[18:19], v7 offset:8704
    ds_read_b64_tr_b16 v[20:21], v7 offset:12288
    ds_read_b64_tr_b16 v[22:23], v7 offset:12800
    ds_read_b64_tr_b16 v[24:25], v7 offset:16384
    ds_read_b64_tr_b16 v[26:27], v7 offset:16896
    ds_read_b64_tr_b16 v[28:29], v7 offset:20480
    ds_read_b64_tr_b16 v[30:31], v7 offset:20992
    v_lshlrev_b32 v6, 5, v3
    s_mul_i32 s6, s25, 768
    s_add_u32 s6, s6, 53248
    v_add_u32 v6, s6, v6
    s_waitcnt vmcnt(0) lgkmcnt(0)
    s_barrier
    s_add_u32 s37, s36, 4096
    ds_read_b128 v[32:35], v6 offset:0
    ds_read_b128 v[40:43], v6 offset:1536
    ds_read_b128 v[36:39], v6 offset:16
    ds_read_b128 v[44:47], v6 offset:1552
    ds_read_b128 v[48:51], v6 offset:128
    ds_read_b128 v[56:59], v6 offset:1664
    ds_read_b128 v[52:55], v6 offset:144
    ds_read_b128 v[60:63], v6 offset:1680
    ds_read_b128 v[64:67], v6 offset:256
    ds_read_b128 v[72:75], v6 offset:1792
    ds_read_b128 v[68:71], v6 offset:272
    ds_read_b128 v[76:79], v6 offset:1808
    s_waitcnt lgkmcnt(8)
    v_lshlrev_b32 v152, 16, v8
    v_and_b32 v153, 0xffff0000, v8
    v_cvt_pk_bf16_f32 v32, v32, v33
    v_lshlrev_b32 v154, 16, v9
    v_and_b32 v155, 0xffff0000, v9
    v_cvt_pk_bf16_f32 v33, v34, v35
    v_lshlrev_b32 v156, 16, v10
    v_and_b32 v157, 0xffff0000, v10
    v_cvt_pk_bf16_f32 v34, v36, v37
    v_lshlrev_b32 v158, 16, v11
    v_and_b32 v159, 0xffff0000, v11
    v_cvt_pk_bf16_f32 v35, v38, v39
    v_mul_f32 v152, v152, v40
    v_mul_f32 v153, v153, v41
    v_mul_f32 v154, v154, v42
    v_mul_f32 v155, v155, v43
    v_mul_f32 v156, v156, v44
    v_mul_f32 v157, v157, v45
    v_mul_f32 v158, v158, v46
    v_mul_f32 v159, v159, v47
    v_mfma_f32_16x16x32_bf16 v[204:207], v[32:35], v[8:11], 0
    v_cvt_pk_bf16_f32 v128, v152, v153
    v_cvt_pk_bf16_f32 v129, v154, v155
    v_cvt_pk_bf16_f32 v130, v156, v157
    v_cvt_pk_bf16_f32 v131, v158, v159
    s_nop 1
    v_mfma_f32_16x16x32_bf16 v[200:203], v[192:195], v[128:131], 0
    buffer_store_dwordx4 v[128:131], v4, s[8:11], s36 offen sc1
    s_waitcnt lgkmcnt(4)
    v_lshlrev_b32 v152, 16, v12
    v_and_b32 v153, 0xffff0000, v12
    v_cvt_pk_bf16_f32 v48, v48, v49
    v_lshlrev_b32 v154, 16, v13
    v_and_b32 v155, 0xffff0000, v13
    v_cvt_pk_bf16_f32 v49, v50, v51
    v_lshlrev_b32 v156, 16, v14
    v_and_b32 v157, 0xffff0000, v14
    v_cvt_pk_bf16_f32 v50, v52, v53
    v_lshlrev_b32 v158, 16, v15
    v_and_b32 v159, 0xffff0000, v15
    v_cvt_pk_bf16_f32 v51, v54, v55
    v_mul_f32 v152, v152, v56
    v_mul_f32 v153, v153, v57
    v_mul_f32 v154, v154, v58
    v_mul_f32 v155, v155, v59
    v_mul_f32 v156, v156, v60
    v_mul_f32 v157, v157, v61
    v_mul_f32 v158, v158, v62
    v_mul_f32 v159, v159, v63
    v_mfma_f32_16x16x32_bf16 v[204:207], v[48:51], v[12:15], v[204:207]
    v_cvt_pk_bf16_f32 v132, v152, v153
    v_cvt_pk_bf16_f32 v133, v154, v155
    v_cvt_pk_bf16_f32 v134, v156, v157
    v_cvt_pk_bf16_f32 v135, v158, v159
    s_nop 1
    v_mfma_f32_16x16x32_bf16 v[200:203], v[192:195], v[132:135], v[200:203]
    buffer_store_dwordx4 v[132:135], v4, s[8:11], s36 offen offset:1024 sc1
    s_waitcnt lgkmcnt(0)
    v_lshlrev_b32 v152, 16, v16
    v_and_b32 v153, 0xffff0000, v16
    v_cvt_pk_bf16_f32 v64, v64, v65
    v_lshlrev_b32 v154, 16, v17
    v_and_b32 v155, 0xffff0000, v17
    v_cvt_pk_bf16_f32 v65, v66, v67
    v_lshlrev_b32 v156, 16, v18
    v_and_b32 v157, 0xffff0000, v18
    v_cvt_pk_bf16_f32 v66, v68, v69
    v_lshlrev_b32 v158, 16, v19
    v_and_b32 v159, 0xffff0000, v19
    v_cvt_pk_bf16_f32 v67, v70, v71
    v_mul_f32 v152, v152, v72
    v_mul_f32 v153, v153, v73
    v_mul_f32 v154, v154, v74
    v_mul_f32 v155, v155, v75
    v_mul_f32 v156, v156, v76
    v_mul_f32 v157, v157, v77
    v_mul_f32 v158, v158, v78
    v_mul_f32 v159, v159, v79
    v_mfma_f32_16x16x32_bf16 v[204:207], v[64:67], v[16:19], v[204:207]
    v_cvt_pk_bf16_f32 v136, v152, v153
    v_cvt_pk_bf16_f32 v137, v154, v155
    v_cvt_pk_bf16_f32 v138, v156, v157
    v_cvt_pk_bf16_f32 v139, v158, v159
    s_nop 1
    v_mfma_f32_16x16x32_bf16 v[200:203], v[192:195], v[136:139], v[200:203]
    buffer_store_dwordx4 v[136:139], v4, s[8:11], s36 offen offset:2048 sc1
    ds_read_b128 v[80:83], v6 offset:384
    ds_read_b128 v[88:91], v6 offset:1920
    ds_read_b128 v[84:87], v6 offset:400
    ds_read_b128 v[92:95], v6 offset:1936
    ds_read_b128 v[96:99], v6 offset:512
    ds_read_b128 v[104:107], v6 offset:2048
    ds_read_b128 v[100:103], v6 offset:528
    ds_read_b128 v[108:111], v6 offset:2064
    ds_read_b128 v[112:115], v6 offset:640
    ds_read_b128 v[120:123], v6 offset:2176
    ds_read_b128 v[116:119], v6 offset:656
    ds_read_b128 v[124:127], v6 offset:2192
    s_waitcnt lgkmcnt(8)
    v_lshlrev_b32 v152, 16, v20
    v_and_b32 v153, 0xffff0000, v20
    v_cvt_pk_bf16_f32 v80, v80, v81
    v_lshlrev_b32 v154, 16, v21
    v_and_b32 v155, 0xffff0000, v21
    v_cvt_pk_bf16_f32 v81, v82, v83
    v_lshlrev_b32 v156, 16, v22
    v_and_b32 v157, 0xffff0000, v22
    v_cvt_pk_bf16_f32 v82, v84, v85
    v_lshlrev_b32 v158, 16, v23
    v_and_b32 v159, 0xffff0000, v23
    v_cvt_pk_bf16_f32 v83, v86, v87
    v_mul_f32 v152, v152, v88
    v_mul_f32 v153, v153, v89
    v_mul_f32 v154, v154, v90
    v_mul_f32 v155, v155, v91
    v_mul_f32 v156, v156, v92
    v_mul_f32 v157, v157, v93
    v_mul_f32 v158, v158, v94
    v_mul_f32 v159, v159, v95
    v_mfma_f32_16x16x32_bf16 v[204:207], v[80:83], v[20:23], v[204:207]
    v_cvt_pk_bf16_f32 v140, v152, v153
    v_cvt_pk_bf16_f32 v141, v154, v155
    v_cvt_pk_bf16_f32 v142, v156, v157
    v_cvt_pk_bf16_f32 v143, v158, v159
    s_nop 1
    v_mfma_f32_16x16x32_bf16 v[200:203], v[192:195], v[140:143], v[200:203]
    buffer_store_dwordx4 v[140:143], v4, s[8:11], s36 offen offset:3072 sc1
    s_waitcnt lgkmcnt(4)
    v_lshlrev_b32 v152, 16, v24
    v_and_b32 v153, 0xffff0000, v24
    v_cvt_pk_bf16_f32 v96, v96, v97
    v_lshlrev_b32 v154, 16, v25
    v_and_b32 v155, 0xffff0000, v25
    v_cvt_pk_bf16_f32 v97, v98, v99
    v_lshlrev_b32 v156, 16, v26
    v_and_b32 v157, 0xffff0000, v26
    v_cvt_pk_bf16_f32 v98, v100, v101
    v_lshlrev_b32 v158, 16, v27
    v_and_b32 v159, 0xffff0000, v27
    v_cvt_pk_bf16_f32 v99, v102, v103
    v_mul_f32 v152, v152, v104
    v_mul_f32 v153, v153, v105
    v_mul_f32 v154, v154, v106
    v_mul_f32 v155, v155, v107
    v_mul_f32 v156, v156, v108
    v_mul_f32 v157, v157, v109
    v_mul_f32 v158, v158, v110
    v_mul_f32 v159, v159, v111
    v_mfma_f32_16x16x32_bf16 v[204:207], v[96:99], v[24:27], v[204:207]
    v_cvt_pk_bf16_f32 v144, v152, v153
    v_cvt_pk_bf16_f32 v145, v154, v155
    v_cvt_pk_bf16_f32 v146, v156, v157
    v_cvt_pk_bf16_f32 v147, v158, v159
    s_nop 1
    v_mfma_f32_16x16x32_bf16 v[200:203], v[192:195], v[144:147], v[200:203]
    buffer_store_dwordx4 v[144:147], v4, s[8:11], s37 offen sc1
    s_waitcnt lgkmcnt(0)
    v_lshlrev_b32 v152, 16, v28
    v_and_b32 v153, 0xffff0000, v28
    v_cvt_pk_bf16_f32 v112, v112, v113
    v_lshlrev_b32 v154, 16, v29
    v_and_b32 v155, 0xffff0000, v29
    v_cvt_pk_bf16_f32 v113, v114, v115
    v_lshlrev_b32 v156, 16, v30
    v_and_b32 v157, 0xffff0000, v30
    v_cvt_pk_bf16_f32 v114, v116, v117
    v_lshlrev_b32 v158, 16, v31
    v_and_b32 v159, 0xffff0000, v31
    v_cvt_pk_bf16_f32 v115, v118, v119
    v_mul_f32 v152, v152, v120
    v_mul_f32 v153, v153, v121
    v_mul_f32 v154, v154, v122
    v_mul_f32 v155, v155, v123
    v_mul_f32 v156, v156, v124
    v_mul_f32 v157, v157, v125
    v_mul_f32 v158, v158, v126
    v_mul_f32 v159, v159, v127
    v_mfma_f32_16x16x32_bf16 v[204:207], v[112:115], v[28:31], v[204:207]
    v_cvt_pk_bf16_f32 v148, v152, v153
    v_cvt_pk_bf16_f32 v149, v154, v155
    v_cvt_pk_bf16_f32 v150, v156, v157
    v_cvt_pk_bf16_f32 v151, v158, v159
    s_nop 1
    v_mfma_f32_16x16x32_bf16 v[200:203], v[192:195], v[148:151], v[200:203]
    buffer_store_dwordx4 v[148:151], v4, s[8:11], s37 offen offset:1024 sc1
    s_add_u32 s36, s36, 0x120000
    s_add_u32 s37, s36, 4096
    ds_read_b128 v[32:35], v6 offset:3072
    ds_read_b128 v[40:43], v6 offset:4608
    ds_read_b128 v[36:39], v6 offset:3088
    ds_read_b128 v[44:47], v6 offset:4624
    ds_read_b128 v[48:51], v6 offset:3200
    ds_read_b128 v[56:59], v6 offset:4736
    ds_read_b128 v[52:55], v6 offset:3216
    ds_read_b128 v[60:63], v6 offset:4752
    ds_read_b128 v[64:67], v6 offset:3328
    ds_read_b128 v[72:75], v6 offset:4864
    ds_read_b128 v[68:71], v6 offset:3344
    ds_read_b128 v[76:79], v6 offset:4880
    s_waitcnt lgkmcnt(8)
    v_lshlrev_b32 v152, 16, v8
    v_and_b32 v153, 0xffff0000, v8
    v_cvt_pk_bf16_f32 v32, v32, v33
    v_lshlrev_b32 v154, 16, v9
    v_and_b32 v155, 0xffff0000, v9
    v_cvt_pk_bf16_f32 v33, v34, v35
    v_lshlrev_b32 v156, 16, v10
    v_and_b32 v157, 0xffff0000, v10
    v_cvt_pk_bf16_f32 v34, v36, v37
    v_lshlrev_b32 v158, 16, v11
    v_and_b32 v159, 0xffff0000, v11
    v_cvt_pk_bf16_f32 v35, v38, v39
    v_mul_f32 v152, v152, v40
    v_mul_f32 v153, v153, v41
    v_mul_f32 v154, v154, v42
    v_mul_f32 v155, v155, v43
    v_mul_f32 v156, v156, v44
    v_mul_f32 v157, v157, v45
    v_mul_f32 v158, v158, v46
    v_mul_f32 v159, v159, v47
    v_mfma_f32_16x16x32_bf16 v[212:215], v[32:35], v[8:11], 0
    v_cvt_pk_bf16_f32 v128, v152, v153
    v_cvt_pk_bf16_f32 v129, v154, v155
    v_cvt_pk_bf16_f32 v130, v156, v157
    v_cvt_pk_bf16_f32 v131, v158, v159
    s_nop 1
    v_mfma_f32_16x16x32_bf16 v[208:211], v[192:195], v[128:131], 0
    buffer_store_dwordx4 v[128:131], v4, s[8:11], s36 offen sc1
    s_waitcnt lgkmcnt(4)
    v_lshlrev_b32 v152, 16, v12
    v_and_b32 v153, 0xffff0000, v12
    v_cvt_pk_bf16_f32 v48, v48, v49
    v_lshlrev_b32 v154, 16, v13
    v_and_b32 v155, 0xffff0000, v13
    v_cvt_pk_bf16_f32 v49, v50, v51
    v_lshlrev_b32 v156, 16, v14
    v_and_b32 v157, 0xffff0000, v14
    v_cvt_pk_bf16_f32 v50, v52, v53
    v_lshlrev_b32 v158, 16, v15
    v_and_b32 v159, 0xffff0000, v15
    v_cvt_pk_bf16_f32 v51, v54, v55
    v_mul_f32 v152, v152, v56
    v_mul_f32 v153, v153, v57
    v_mul_f32 v154, v154, v58
    v_mul_f32 v155, v155, v59
    v_mul_f32 v156, v156, v60
    v_mul_f32 v157, v157, v61
    v_mul_f32 v158, v158, v62
    v_mul_f32 v159, v159, v63
    v_mfma_f32_16x16x32_bf16 v[212:215], v[48:51], v[12:15], v[212:215]
    v_cvt_pk_bf16_f32 v132, v152, v153
    v_cvt_pk_bf16_f32 v133, v154, v155
    v_cvt_pk_bf16_f32 v134, v156, v157
    v_cvt_pk_bf16_f32 v135, v158, v159
    s_nop 1
    v_mfma_f32_16x16x32_bf16 v[208:211], v[192:195], v[132:135], v[208:211]
    buffer_store_dwordx4 v[132:135], v4, s[8:11], s36 offen offset:1024 sc1
    s_waitcnt lgkmcnt(0)
    v_lshlrev_b32 v152, 16, v16
    v_and_b32 v153, 0xffff0000, v16
    v_cvt_pk_bf16_f32 v64, v64, v65
    v_lshlrev_b32 v154, 16, v17
    v_and_b32 v155, 0xffff0000, v17
    v_cvt_pk_bf16_f32 v65, v66, v67
    v_lshlrev_b32 v156, 16, v18
    v_and_b32 v157, 0xffff0000, v18
    v_cvt_pk_bf16_f32 v66, v68, v69
    v_lshlrev_b32 v158, 16, v19
    v_and_b32 v159, 0xffff0000, v19
    v_cvt_pk_bf16_f32 v67, v70, v71
    v_mul_f32 v152, v152, v72
    v_mul_f32 v153, v153, v73
    v_mul_f32 v154, v154, v74
    v_mul_f32 v155, v155, v75
    v_mul_f32 v156, v156, v76
    v_mul_f32 v157, v157, v77
    v_mul_f32 v158, v158, v78
    v_mul_f32 v159, v159, v79
    v_mfma_f32_16x16x32_bf16 v[212:215], v[64:67], v[16:19], v[212:215]
    v_cvt_pk_bf16_f32 v136, v152, v153
    v_cvt_pk_bf16_f32 v137, v154, v155
    v_cvt_pk_bf16_f32 v138, v156, v157
    v_cvt_pk_bf16_f32 v139, v158, v159
    s_nop 1
    v_mfma_f32_16x16x32_bf16 v[208:211], v[192:195], v[136:139], v[208:211]
    buffer_store_dwordx4 v[136:139], v4, s[8:11], s36 offen offset:2048 sc1
    ds_read_b128 v[80:83], v6 offset:3456
    ds_read_b128 v[88:91], v6 offset:4992
    ds_read_b128 v[84:87], v6 offset:3472
    ds_read_b128 v[92:95], v6 offset:5008
    ds_read_b128 v[96:99], v6 offset:3584
    ds_read_b128 v[104:107], v6 offset:5120
    ds_read_b128 v[100:103], v6 offset:3600
    ds_read_b128 v[108:111], v6 offset:5136
    ds_read_b128 v[112:115], v6 offset:3712
    ds_read_b128 v[120:123], v6 offset:5248
    ds_read_b128 v[116:119], v6 offset:3728
    ds_read_b128 v[124:127], v6 offset:5264
    s_waitcnt lgkmcnt(8)
    v_lshlrev_b32 v152, 16, v20
    v_and_b32 v153, 0xffff0000, v20
    v_cvt_pk_bf16_f32 v80, v80, v81
    v_lshlrev_b32 v154, 16, v21
    v_and_b32 v155, 0xffff0000, v21
    v_cvt_pk_bf16_f32 v81, v82, v83
    v_lshlrev_b32 v156, 16, v22
    v_and_b32 v157, 0xffff0000, v22
    v_cvt_pk_bf16_f32 v82, v84, v85
    v_lshlrev_b32 v158, 16, v23
    v_and_b32 v159, 0xffff0000, v23
    v_cvt_pk_bf16_f32 v83, v86, v87
    v_mul_f32 v152, v152, v88
    v_mul_f32 v153, v153, v89
    v_mul_f32 v154, v154, v90
    v_mul_f32 v155, v155, v91
    v_mul_f32 v156, v156, v92
    v_mul_f32 v157, v157, v93
    v_mul_f32 v158, v158, v94
    v_mul_f32 v159, v159, v95
    v_mfma_f32_16x16x32_bf16 v[212:215], v[80:83], v[20:23], v[212:215]
    v_cvt_pk_bf16_f32 v140, v152, v153
    v_cvt_pk_bf16_f32 v141, v154, v155
    v_cvt_pk_bf16_f32 v142, v156, v157
    v_cvt_pk_bf16_f32 v143, v158, v159
    s_nop 1
    v_mfma_f32_16x16x32_bf16 v[208:211], v[192:195], v[140:143], v[208:211]
    buffer_store_dwordx4 v[140:143], v4, s[8:11], s36 offen offset:3072 sc1
    s_waitcnt lgkmcnt(4)
    v_lshlrev_b32 v152, 16, v24
    v_and_b32 v153, 0xffff0000, v24
    v_cvt_pk_bf16_f32 v96, v96, v97
    v_lshlrev_b32 v154, 16, v25
    v_and_b32 v155, 0xffff0000, v25
    v_cvt_pk_bf16_f32 v97, v98, v99
    v_lshlrev_b32 v156, 16, v26
    v_and_b32 v157, 0xffff0000, v26
    v_cvt_pk_bf16_f32 v98, v100, v101
    v_lshlrev_b32 v158, 16, v27
    v_and_b32 v159, 0xffff0000, v27
    v_cvt_pk_bf16_f32 v99, v102, v103
    v_mul_f32 v152, v152, v104
    v_mul_f32 v153, v153, v105
    v_mul_f32 v154, v154, v106
    v_mul_f32 v155, v155, v107
    v_mul_f32 v156, v156, v108
    v_mul_f32 v157, v157, v109
    v_mul_f32 v158, v158, v110
    v_mul_f32 v159, v159, v111
    v_mfma_f32_16x16x32_bf16 v[212:215], v[96:99], v[24:27], v[212:215]
    v_cvt_pk_bf16_f32 v144, v152, v153
    v_cvt_pk_bf16_f32 v145, v154, v155
    v_cvt_pk_bf16_f32 v146, v156, v157
    v_cvt_pk_bf16_f32 v147, v158, v159
    s_nop 1
    v_mfma_f32_16x16x32_bf16 v[208:211], v[192:195], v[144:147], v[208:211]
    buffer_store_dwordx4 v[144:147], v4, s[8:11], s37 offen sc1
    s_waitcnt lgkmcnt(0)
    v_lshlrev_b32 v152, 16, v28
    v_and_b32 v153, 0xffff0000, v28
    v_cvt_pk_bf16_f32 v112, v112, v113
    v_lshlrev_b32 v154, 16, v29
    v_and_b32 v155, 0xffff0000, v29
    v_cvt_pk_bf16_f32 v113, v114, v115
    v_lshlrev_b32 v156, 16, v30
    v_and_b32 v157, 0xffff0000, v30
    v_cvt_pk_bf16_f32 v114, v116, v117
    v_lshlrev_b32 v158, 16, v31
    v_and_b32 v159, 0xffff0000, v31
    v_cvt_pk_bf16_f32 v115, v118, v119
    v_mul_f32 v152, v152, v120
    v_mul_f32 v153, v153, v121
    v_mul_f32 v154, v154, v122
    v_mul_f32 v155, v155, v123
    v_mul_f32 v156, v156, v124
    v_mul_f32 v157, v157, v125
    v_mul_f32 v158, v158, v126
    v_mul_f32 v159, v159, v127
    v_mfma_f32_16x16x32_bf16 v[212:215], v[112:115], v[28:31], v[212:215]
    v_cvt_pk_bf16_f32 v148, v152, v153
    v_cvt_pk_bf16_f32 v149, v154, v155
    v_cvt_pk_bf16_f32 v150, v156, v157
    v_cvt_pk_bf16_f32 v151, v158, v159
    s_nop 1
    v_mfma_f32_16x16x32_bf16 v[208:211], v[192:195], v[148:151], v[208:211]
    buffer_store_dwordx4 v[148:151], v4, s[8:11], s37 offen offset:1024 sc1
    s_nop 7
    v_mov_b32 v160, v200
    v_mov_b32 v161, v204
    v_mov_b32 v162, v208
    v_mov_b32 v163, v212
    s_lshr_b32 s6, s3, 1
    s_lshl_b32 s6, s6, 10
    s_add_u32 s6, s6, 49152
    v_add_u32 v5, s6, v4
    s_lshl_b32 s35, s24, 2
    s_add_u32 s35, s35, 1024
    s_cmp_eq_u32 s25, 0
    s_cbranch_scc1 L_standalone__dit_block__diffusion_kernel_f1
    ds_write_b128 v5, v[160:163]
    s_waitcnt lgkmcnt(0)
    s_barrier
    s_branch L_standalone__dit_block__diffusion_kernel_p1e
L_standalone__dit_block__diffusion_kernel_f1:
    s_barrier
    ds_read_b128 v[152:155], v5
    s_lshl_b32 s6, s27, 6
    s_add_u32 s6, s6, 0x8000
    v_lshlrev_b32 v5, 2, v2
    s_waitcnt lgkmcnt(0)
    v_add_f32 v160, v160, v152
    buffer_store_dword v160, v5, s[8:11], s6 offen sc1
    s_add_u32 s6, s6, 6144
    v_add_f32 v161, v161, v153
    buffer_store_dword v161, v5, s[8:11], s6 offen sc1
    s_add_u32 s6, s6, 6144
    v_add_f32 v162, v162, v154
    buffer_store_dword v162, v5, s[8:11], s6 offen sc1
    s_add_u32 s6, s6, 6144
    v_add_f32 v163, v163, v155
    buffer_store_dword v163, v5, s[8:11], s6 offen sc1
    s_add_u32 s6, s6, 6144
    s_branch L_standalone__dit_block__diffusion_kernel_p1e
L_standalone__dit_block__diffusion_kernel_gemm:
    s_sub_u32 s6, s2, 64
    s_lshl_b32 s6, s6, 1
    s_and_b32 s7, s3, 1
    s_add_u32 s6, s6, s7
    s_lshl_b32 s6, s6, 12
    v_lshlrev_b32 v7, 2, v4
    s_lshr_b32 s7, s3, 1
    s_cmp_lg_u32 s7, 0
    s_cbranch_scc1 L_standalone__dit_block__diffusion_kernel_ta0
    buffer_load_dword v199, v7, s[24:27], s6 offen
L_standalone__dit_block__diffusion_kernel_ta0:
    s_cmp_lg_u32 s7, 1
    s_cbranch_scc1 L_standalone__dit_block__diffusion_kernel_ta1
    buffer_load_dword v199, v7, s[20:23], s6 offen
L_standalone__dit_block__diffusion_kernel_ta1:
    s_sub_u32 s41, s5, 8
    s_lshl_b32 s28, s4, 1
    s_and_b32 s6, s41, 1
    s_add_u32 s28, s28, s6
    s_lshr_b32 s29, s41, 1
    s_lshl_b32 s42, s28, 3
    s_add_u32 s42, s42, s3
    s_mul_i32 s30, s42, 12288
    s_mov_b32 s6, 0x5555556
    v_lshrrev_b32 v175, 4, v4
    v_add_u32 v175, 0, v175
    v_mul_hi_u32 v172, v175, s6
    v_mul_u32_u24 v176, 48, v172
    v_sub_u32 v175, v175, v176
    v_xor_b32 v175, v175, v172
    v_mul_u32_u24 v172, 768, v172
    v_lshl_add_u32 v172, v175, 4, v172
    v_lshrrev_b32 v175, 4, v4
    v_add_u32 v175, 64, v175
    v_mul_hi_u32 v173, v175, s6
    v_mul_u32_u24 v176, 48, v173
    v_sub_u32 v175, v175, v176
    v_xor_b32 v175, v175, v173
    v_mul_u32_u24 v173, 768, v173
    v_lshl_add_u32 v173, v175, 4, v173
    v_lshrrev_b32 v175, 4, v4
    v_add_u32 v175, 128, v175
    v_mul_hi_u32 v174, v175, s6
    v_mul_u32_u24 v176, 48, v174
    v_sub_u32 v175, v175, v176
    v_xor_b32 v175, v175, v174
    v_mul_u32_u24 v174, 768, v174
    v_lshl_add_u32 v174, v175, 4, v174
    s_mul_i32 s31, s3, 12288
    s_add_u32 s31, s31, 61440
    v_mul_u32_u24 v7, 768, v2
    v_add_u32 v7, s31, v7
    v_xor_b32 v6, v2, v3
    s_mov_b32 m0, s31
    s_add_u32 s31, s31, 1024
    v_xor_b32 v5, 0, v172
    buffer_load_dwordx4 v5, s[12:15], s30 offen lds
    s_mov_b32 m0, s31
    s_add_u32 s31, s31, 1024
    v_xor_b32 v5, 0, v173
    buffer_load_dwordx4 v5, s[12:15], s30 offen lds
    s_mov_b32 m0, s31
    s_add_u32 s31, s31, 1024
    v_xor_b32 v5, 0, v174
    buffer_load_dwordx4 v5, s[12:15], s30 offen lds
    s_add_u32 s30, s30, 3072
    s_mov_b32 m0, s31
    s_add_u32 s31, s31, 1024
    v_xor_b32 v5, 64, v172
    buffer_load_dwordx4 v5, s[12:15], s30 offen lds
    s_mov_b32 m0, s31
    s_add_u32 s31, s31, 1024
    v_xor_b32 v5, 64, v173
    buffer_load_dwordx4 v5, s[12:15], s30 offen lds
    s_mov_b32 m0, s31
    s_add_u32 s31, s31, 1024
    v_xor_b32 v5, 64, v174
    buffer_load_dwordx4 v5, s[12:15], s30 offen lds
    s_add_u32 s30, s30, 3072
    s_mov_b32 m0, s31
    s_add_u32 s31, s31, 1024
    v_xor_b32 v5, 128, v172
    buffer_load_dwordx4 v5, s[12:15], s30 offen lds
    s_mov_b32 m0, s31
    s_add_u32 s31, s31, 1024
    v_xor_b32 v5, 128, v173
    buffer_load_dwordx4 v5, s[12:15], s30 offen lds
    s_mov_b32 m0, s31
    s_add_u32 s31, s31, 1024
    v_xor_b32 v5, 128, v174
    buffer_load_dwordx4 v5, s[12:15], s30 offen lds
    s_add_u32 s30, s30, 3072
    s_mov_b32 m0, s31
    s_add_u32 s31, s31, 1024
    v_xor_b32 v5, 192, v172
    buffer_load_dwordx4 v5, s[12:15], s30 offen lds
    s_mov_b32 m0, s31
    s_add_u32 s31, s31, 1024
    v_xor_b32 v5, 192, v173
    buffer_load_dwordx4 v5, s[12:15], s30 offen lds
    s_mov_b32 m0, s31
    s_add_u32 s31, s31, 1024
    v_xor_b32 v5, 192, v174
    buffer_load_dwordx4 v5, s[12:15], s30 offen lds
    s_add_u32 s30, s30, 3072
    v_xor_b32 v180, 0, v6
    v_lshl_add_u32 v180, v180, 4, v7
    v_xor_b32 v181, 4, v6
    v_lshl_add_u32 v181, v181, 4, v7
    v_xor_b32 v182, 8, v6
    v_lshl_add_u32 v182, v182, 4, v7
    v_xor_b32 v183, 12, v6
    v_lshl_add_u32 v183, v183, 4, v7
    s_mov_b32 s6, 0x15555556
    s_mov_b32 s7, 2304
    v_lshrrev_b32 v160, 4, v4
    v_add_u32 v160, 0, v160
    v_mul_hi_u32 v168, v160, s6
    v_mul_u32_u24 v161, 12, v168
    v_sub_u32 v160, v160, v161
    v_lshrrev_b32 v161, 2, v168
    v_and_b32 v161, 2, v161
    v_xor_b32 v160, v160, v161
    v_mul_lo_u32 v168, v168, s7
    v_lshl_add_u32 v168, v160, 4, v168
    v_lshrrev_b32 v160, 4, v4
    v_add_u32 v160, 64, v160
    v_mul_hi_u32 v169, v160, s6
    v_mul_u32_u24 v161, 12, v169
    v_sub_u32 v160, v160, v161
    v_lshrrev_b32 v161, 2, v169
    v_and_b32 v161, 2, v161
    v_xor_b32 v160, v160, v161
    v_mul_lo_u32 v169, v169, s7
    v_lshl_add_u32 v169, v160, 4, v169
    v_lshrrev_b32 v160, 4, v4
    v_add_u32 v160, 128, v160
    v_mul_hi_u32 v170, v160, s6
    v_mul_u32_u24 v161, 12, v170
    v_sub_u32 v160, v160, v161
    v_lshrrev_b32 v161, 2, v170
    v_and_b32 v161, 2, v161
    v_xor_b32 v160, v160, v161
    v_mul_lo_u32 v170, v170, s7
    v_lshl_add_u32 v170, v160, 4, v170
    s_mul_i32 s36, s3, 3072
    s_mul_i32 s37, s3, 36864
    s_mul_i32 s6, s29, 192
    s_add_u32 s37, s37, s6
    s_waitcnt vmcnt(0) lgkmcnt(0)
    ds_read_b128 v[8:11], v180 offset:0
    ds_read_b128 v[12:15], v181 offset:0
    ds_read_b128 v[16:19], v182 offset:0
    ds_read_b128 v[20:23], v183 offset:0
    ds_read_b128 v[24:27], v180 offset:256
    ds_read_b128 v[28:31], v181 offset:256
    ds_read_b128 v[32:35], v182 offset:256
    ds_read_b128 v[36:39], v183 offset:256
    ds_read_b128 v[40:43], v180 offset:512
    ds_read_b128 v[44:47], v181 offset:512
    ds_read_b128 v[48:51], v182 offset:512
    ds_read_b128 v[52:55], v183 offset:512
    s_mov_b32 m0, s36
    s_add_u32 s36, s36, 1024
    buffer_load_dwordx4 v168, s[24:27], s37 offen lds
    s_mov_b32 m0, s36
    s_add_u32 s36, s36, 1024
    buffer_load_dwordx4 v169, s[24:27], s37 offen lds
    s_mov_b32 m0, s36
    s_add_u32 s36, s36, 1024
    buffer_load_dwordx4 v170, s[24:27], s37 offen lds
    s_add_u32 s36, s36, 21504
    s_add_u32 s37, s37, 294912
    s_mov_b32 m0, s36
    s_add_u32 s36, s36, 1024
    buffer_load_dwordx4 v168, s[24:27], s37 offen lds
    s_mov_b32 m0, s36
    s_add_u32 s36, s36, 1024
    buffer_load_dwordx4 v169, s[24:27], s37 offen lds
    s_mov_b32 m0, s36
    s_add_u32 s36, s36, 1024
    buffer_load_dwordx4 v170, s[24:27], s37 offen lds
    s_add_u32 s36, s36, 21504
    s_add_u32 s37, s37, 294912
    s_waitcnt lgkmcnt(0)
    s_barrier
    v_mov_b32 v192, 0x3f803f80
    v_mov_b32 v193, 0x3f803f80
    v_mov_b32 v194, 0x3f803f80
    v_mov_b32 v195, 0x3f803f80
    s_nop 1
    v_mfma_f32_16x16x32_bf16 v[184:187], v[192:195], v[8:11], 0
    v_mfma_f32_16x16x32_bf16 v[188:191], v[8:11], v[8:11], 0
    v_mfma_f32_16x16x32_bf16 v[184:187], v[192:195], v[12:15], v[184:187]
    v_mfma_f32_16x16x32_bf16 v[188:191], v[12:15], v[12:15], v[188:191]
    v_mfma_f32_16x16x32_bf16 v[184:187], v[192:195], v[16:19], v[184:187]
    v_mfma_f32_16x16x32_bf16 v[188:191], v[16:19], v[16:19], v[188:191]
    v_mfma_f32_16x16x32_bf16 v[184:187], v[192:195], v[20:23], v[184:187]
    v_mfma_f32_16x16x32_bf16 v[188:191], v[20:23], v[20:23], v[188:191]
    v_mfma_f32_16x16x32_bf16 v[184:187], v[192:195], v[24:27], v[184:187]
    v_mfma_f32_16x16x32_bf16 v[188:191], v[24:27], v[24:27], v[188:191]
    v_mfma_f32_16x16x32_bf16 v[184:187], v[192:195], v[28:31], v[184:187]
    v_mfma_f32_16x16x32_bf16 v[188:191], v[28:31], v[28:31], v[188:191]
    v_mfma_f32_16x16x32_bf16 v[184:187], v[192:195], v[32:35], v[184:187]
    v_mfma_f32_16x16x32_bf16 v[188:191], v[32:35], v[32:35], v[188:191]
    v_mfma_f32_16x16x32_bf16 v[184:187], v[192:195], v[36:39], v[184:187]
    v_mfma_f32_16x16x32_bf16 v[188:191], v[36:39], v[36:39], v[188:191]
    v_mfma_f32_16x16x32_bf16 v[184:187], v[192:195], v[40:43], v[184:187]
    v_mfma_f32_16x16x32_bf16 v[188:191], v[40:43], v[40:43], v[188:191]
    v_mfma_f32_16x16x32_bf16 v[184:187], v[192:195], v[44:47], v[184:187]
    v_mfma_f32_16x16x32_bf16 v[188:191], v[44:47], v[44:47], v[188:191]
    v_mfma_f32_16x16x32_bf16 v[184:187], v[192:195], v[48:51], v[184:187]
    v_mfma_f32_16x16x32_bf16 v[188:191], v[48:51], v[48:51], v[188:191]
    v_mfma_f32_16x16x32_bf16 v[184:187], v[192:195], v[52:55], v[184:187]
    v_mfma_f32_16x16x32_bf16 v[188:191], v[52:55], v[52:55], v[188:191]
    s_mov_b32 m0, s36
    s_add_u32 s36, s36, 1024
    buffer_load_dwordx4 v168, s[24:27], s37 offen lds
    s_mov_b32 m0, s36
    s_add_u32 s36, s36, 1024
    buffer_load_dwordx4 v169, s[24:27], s37 offen lds
    s_mov_b32 m0, s36
    s_add_u32 s36, s36, 1024
    buffer_load_dwordx4 v170, s[24:27], s37 offen lds
    s_mov_b32 s6, 0x15555556
    s_mov_b32 s7, 768
    v_lshrrev_b32 v175, 4, v4
    v_add_u32 v175, 0, v175
    v_mul_hi_u32 v172, v175, s6
    v_mul_u32_u24 v176, 12, v172
    v_sub_u32 v175, v175, v176
    v_lshrrev_b32 v176, 2, v172
    v_and_b32 v176, 2, v176
    v_xor_b32 v175, v175, v176
    v_mul_lo_u32 v172, v172, s7
    v_lshl_add_u32 v172, v175, 4, v172
    v_lshrrev_b32 v175, 4, v4
    v_add_u32 v175, 64, v175
    v_mul_hi_u32 v173, v175, s6
    v_mul_u32_u24 v176, 12, v173
    v_sub_u32 v175, v175, v176
    v_lshrrev_b32 v176, 2, v173
    v_and_b32 v176, 2, v176
    v_xor_b32 v175, v175, v176
    v_mul_lo_u32 v173, v173, s7
    v_lshl_add_u32 v173, v175, 4, v173
    v_lshrrev_b32 v175, 4, v4
    v_add_u32 v175, 128, v175
    v_mul_hi_u32 v174, v175, s6
    v_mul_u32_u24 v176, 12, v174
    v_sub_u32 v175, v175, v176
    v_lshrrev_b32 v176, 2, v174
    v_and_b32 v176, 2, v176
    v_xor_b32 v175, v175, v176
    v_mul_lo_u32 v174, v174, s7
    v_lshl_add_u32 v174, v175, 4, v174
    s_mul_i32 s36, s3, 9216
    s_add_u32 s36, s36, 77824
    s_mul_i32 s37, s3, 36864
    s_mul_i32 s6, s49, 192
    s_add_u32 s37, s37, s6
    v_lshlrev_b32 v56, 16, v8
    v_and_b32 v57, 0xffff0000, v8
    v_lshlrev_b32 v58, 16, v9
    v_and_b32 v59, 0xffff0000, v9
    v_lshlrev_b32 v60, 16, v10
    v_and_b32 v61, 0xffff0000, v10
    v_lshlrev_b32 v62, 16, v11
    v_and_b32 v63, 0xffff0000, v11
    v_lshlrev_b32 v64, 16, v12
    v_and_b32 v65, 0xffff0000, v12
    v_lshlrev_b32 v66, 16, v13
    v_and_b32 v67, 0xffff0000, v13
    v_lshlrev_b32 v68, 16, v14
    v_and_b32 v69, 0xffff0000, v14
    v_lshlrev_b32 v70, 16, v15
    v_and_b32 v71, 0xffff0000, v15
    v_lshlrev_b32 v72, 16, v16
    v_and_b32 v73, 0xffff0000, v16
    v_lshlrev_b32 v74, 16, v17
    v_and_b32 v75, 0xffff0000, v17
    v_lshlrev_b32 v76, 16, v18
    v_and_b32 v77, 0xffff0000, v18
    v_lshlrev_b32 v78, 16, v19
    v_and_b32 v79, 0xffff0000, v19
    v_lshlrev_b32 v80, 16, v20
    v_and_b32 v81, 0xffff0000, v20
    v_lshlrev_b32 v82, 16, v21
    v_and_b32 v83, 0xffff0000, v21
    v_lshlrev_b32 v84, 16, v22
    v_and_b32 v85, 0xffff0000, v22
    v_lshlrev_b32 v86, 16, v23
    v_and_b32 v87, 0xffff0000, v23
    v_lshlrev_b32 v88, 16, v24
    v_and_b32 v89, 0xffff0000, v24
    v_lshlrev_b32 v90, 16, v25
    v_and_b32 v91, 0xffff0000, v25
    v_lshlrev_b32 v92, 16, v26
    v_and_b32 v93, 0xffff0000, v26
    v_lshlrev_b32 v94, 16, v27
    v_and_b32 v95, 0xffff0000, v27
    v_lshlrev_b32 v96, 16, v28
    v_and_b32 v97, 0xffff0000, v28
    v_lshlrev_b32 v98, 16, v29
    v_and_b32 v99, 0xffff0000, v29
    v_lshlrev_b32 v100, 16, v30
    v_and_b32 v101, 0xffff0000, v30
    v_lshlrev_b32 v102, 16, v31
    v_and_b32 v103, 0xffff0000, v31
    v_lshlrev_b32 v200, 16, v32
    v_and_b32 v201, 0xffff0000, v32
    v_lshlrev_b32 v202, 16, v33
    v_and_b32 v203, 0xffff0000, v33
    v_lshlrev_b32 v204, 16, v34
    v_and_b32 v205, 0xffff0000, v34
    v_lshlrev_b32 v206, 16, v35
    v_and_b32 v207, 0xffff0000, v35
    v_lshlrev_b32 v208, 16, v36
    v_and_b32 v209, 0xffff0000, v36
    v_lshlrev_b32 v210, 16, v37
    v_and_b32 v211, 0xffff0000, v37
    v_lshlrev_b32 v212, 16, v38
    v_and_b32 v213, 0xffff0000, v38
    v_lshlrev_b32 v214, 16, v39
    v_and_b32 v215, 0xffff0000, v39
    v_lshlrev_b32 v216, 16, v40
    v_and_b32 v217, 0xffff0000, v40
    v_lshlrev_b32 v218, 16, v41
    v_and_b32 v219, 0xffff0000, v41
    v_lshlrev_b32 v220, 16, v42
    v_and_b32 v221, 0xffff0000, v42
    v_lshlrev_b32 v222, 16, v43
    v_and_b32 v223, 0xffff0000, v43
    v_lshlrev_b32 v224, 16, v44
    v_and_b32 v225, 0xffff0000, v44
    v_lshlrev_b32 v226, 16, v45
    v_and_b32 v227, 0xffff0000, v45
    v_lshlrev_b32 v228, 16, v46
    v_and_b32 v229, 0xffff0000, v46
    v_lshlrev_b32 v230, 16, v47
    v_and_b32 v231, 0xffff0000, v47
    v_lshlrev_b32 v232, 16, v48
    v_and_b32 v233, 0xffff0000, v48
    v_lshlrev_b32 v234, 16, v49
    v_and_b32 v235, 0xffff0000, v49
    v_lshlrev_b32 v236, 16, v50
    v_and_b32 v237, 0xffff0000, v50
    v_lshlrev_b32 v238, 16, v51
    v_and_b32 v239, 0xffff0000, v51
    v_lshlrev_b32 v240, 16, v52
    v_and_b32 v241, 0xffff0000, v52
    v_lshlrev_b32 v242, 16, v53
    v_and_b32 v243, 0xffff0000, v53
    v_lshlrev_b32 v244, 16, v54
    v_and_b32 v245, 0xffff0000, v54
    v_lshlrev_b32 v246, 16, v55
    v_and_b32 v247, 0xffff0000, v55
    v_and_b32 v162, 1, v2
    v_cmp_eq_u32 vcc, 0, v162
    v_and_b32 v162, 2, v2
    v_lshrrev_b32 v163, 2, v2
    v_cndmask_b32 v188, v189, v188, vcc
    v_cndmask_b32 v190, v191, v190, vcc
    v_cmp_eq_u32 vcc, 0, v162
    v_mul_f32 v160, 0x3b2aaaab, v184
    s_nop 0
    v_cndmask_b32 v188, v190, v188, vcc
    v_cmp_eq_u32 vcc, v3, v163
    s_nop 1
    v_cndmask_b32 v161, 0, v188, vcc
    v_mov_b32 v162, v161
    s_nop 1
    v_permlane32_swap_b32 v161, v162
    s_nop 1
    v_add_f32 v161, v161, v162
    v_mov_b32 v162, v161
    s_nop 1
    v_permlane16_swap_b32 v161, v162
    s_nop 1
    v_add_f32 v161, v161, v162
    v_mul_f32 v161, 0x3b2aaaab, v161
    v_fma_f32 v161, -v160, v160, v161
    v_max_f32 v161, 0, v161
    v_add_f32 v161, 0x3727c5ac, v161
    v_rsq_f32 v161, v161
    s_nop 0
    v_mul_f32 v160, v160, v161
    v_pk_fma_f32 v[56:57], v[56:57], v[160:161], v[160:161] op_sel:[0,1,0] op_sel_hi:[1,1,0] neg_lo:[0,0,1] neg_hi:[0,0,1]
    v_pk_fma_f32 v[58:59], v[58:59], v[160:161], v[160:161] op_sel:[0,1,0] op_sel_hi:[1,1,0] neg_lo:[0,0,1] neg_hi:[0,0,1]
    v_pk_fma_f32 v[60:61], v[60:61], v[160:161], v[160:161] op_sel:[0,1,0] op_sel_hi:[1,1,0] neg_lo:[0,0,1] neg_hi:[0,0,1]
    v_pk_fma_f32 v[62:63], v[62:63], v[160:161], v[160:161] op_sel:[0,1,0] op_sel_hi:[1,1,0] neg_lo:[0,0,1] neg_hi:[0,0,1]
    v_pk_fma_f32 v[64:65], v[64:65], v[160:161], v[160:161] op_sel:[0,1,0] op_sel_hi:[1,1,0] neg_lo:[0,0,1] neg_hi:[0,0,1]
    v_pk_fma_f32 v[66:67], v[66:67], v[160:161], v[160:161] op_sel:[0,1,0] op_sel_hi:[1,1,0] neg_lo:[0,0,1] neg_hi:[0,0,1]
    v_pk_fma_f32 v[68:69], v[68:69], v[160:161], v[160:161] op_sel:[0,1,0] op_sel_hi:[1,1,0] neg_lo:[0,0,1] neg_hi:[0,0,1]
    v_pk_fma_f32 v[70:71], v[70:71], v[160:161], v[160:161] op_sel:[0,1,0] op_sel_hi:[1,1,0] neg_lo:[0,0,1] neg_hi:[0,0,1]
    v_pk_fma_f32 v[72:73], v[72:73], v[160:161], v[160:161] op_sel:[0,1,0] op_sel_hi:[1,1,0] neg_lo:[0,0,1] neg_hi:[0,0,1]
    v_pk_fma_f32 v[74:75], v[74:75], v[160:161], v[160:161] op_sel:[0,1,0] op_sel_hi:[1,1,0] neg_lo:[0,0,1] neg_hi:[0,0,1]
    v_pk_fma_f32 v[76:77], v[76:77], v[160:161], v[160:161] op_sel:[0,1,0] op_sel_hi:[1,1,0] neg_lo:[0,0,1] neg_hi:[0,0,1]
    v_pk_fma_f32 v[78:79], v[78:79], v[160:161], v[160:161] op_sel:[0,1,0] op_sel_hi:[1,1,0] neg_lo:[0,0,1] neg_hi:[0,0,1]
    v_pk_fma_f32 v[80:81], v[80:81], v[160:161], v[160:161] op_sel:[0,1,0] op_sel_hi:[1,1,0] neg_lo:[0,0,1] neg_hi:[0,0,1]
    v_pk_fma_f32 v[82:83], v[82:83], v[160:161], v[160:161] op_sel:[0,1,0] op_sel_hi:[1,1,0] neg_lo:[0,0,1] neg_hi:[0,0,1]
    v_pk_fma_f32 v[84:85], v[84:85], v[160:161], v[160:161] op_sel:[0,1,0] op_sel_hi:[1,1,0] neg_lo:[0,0,1] neg_hi:[0,0,1]
    v_pk_fma_f32 v[86:87], v[86:87], v[160:161], v[160:161] op_sel:[0,1,0] op_sel_hi:[1,1,0] neg_lo:[0,0,1] neg_hi:[0,0,1]
    v_pk_fma_f32 v[88:89], v[88:89], v[160:161], v[160:161] op_sel:[0,1,0] op_sel_hi:[1,1,0] neg_lo:[0,0,1] neg_hi:[0,0,1]
    v_pk_fma_f32 v[90:91], v[90:91], v[160:161], v[160:161] op_sel:[0,1,0] op_sel_hi:[1,1,0] neg_lo:[0,0,1] neg_hi:[0,0,1]
    v_pk_fma_f32 v[92:93], v[92:93], v[160:161], v[160:161] op_sel:[0,1,0] op_sel_hi:[1,1,0] neg_lo:[0,0,1] neg_hi:[0,0,1]
    v_pk_fma_f32 v[94:95], v[94:95], v[160:161], v[160:161] op_sel:[0,1,0] op_sel_hi:[1,1,0] neg_lo:[0,0,1] neg_hi:[0,0,1]
    v_pk_fma_f32 v[96:97], v[96:97], v[160:161], v[160:161] op_sel:[0,1,0] op_sel_hi:[1,1,0] neg_lo:[0,0,1] neg_hi:[0,0,1]
    v_pk_fma_f32 v[98:99], v[98:99], v[160:161], v[160:161] op_sel:[0,1,0] op_sel_hi:[1,1,0] neg_lo:[0,0,1] neg_hi:[0,0,1]
    v_pk_fma_f32 v[100:101], v[100:101], v[160:161], v[160:161] op_sel:[0,1,0] op_sel_hi:[1,1,0] neg_lo:[0,0,1] neg_hi:[0,0,1]
    v_pk_fma_f32 v[102:103], v[102:103], v[160:161], v[160:161] op_sel:[0,1,0] op_sel_hi:[1,1,0] neg_lo:[0,0,1] neg_hi:[0,0,1]
    v_pk_fma_f32 v[200:201], v[200:201], v[160:161], v[160:161] op_sel:[0,1,0] op_sel_hi:[1,1,0] neg_lo:[0,0,1] neg_hi:[0,0,1]
    v_pk_fma_f32 v[202:203], v[202:203], v[160:161], v[160:161] op_sel:[0,1,0] op_sel_hi:[1,1,0] neg_lo:[0,0,1] neg_hi:[0,0,1]
    v_pk_fma_f32 v[204:205], v[204:205], v[160:161], v[160:161] op_sel:[0,1,0] op_sel_hi:[1,1,0] neg_lo:[0,0,1] neg_hi:[0,0,1]
    v_pk_fma_f32 v[206:207], v[206:207], v[160:161], v[160:161] op_sel:[0,1,0] op_sel_hi:[1,1,0] neg_lo:[0,0,1] neg_hi:[0,0,1]
    v_pk_fma_f32 v[208:209], v[208:209], v[160:161], v[160:161] op_sel:[0,1,0] op_sel_hi:[1,1,0] neg_lo:[0,0,1] neg_hi:[0,0,1]
    v_pk_fma_f32 v[210:211], v[210:211], v[160:161], v[160:161] op_sel:[0,1,0] op_sel_hi:[1,1,0] neg_lo:[0,0,1] neg_hi:[0,0,1]
    v_pk_fma_f32 v[212:213], v[212:213], v[160:161], v[160:161] op_sel:[0,1,0] op_sel_hi:[1,1,0] neg_lo:[0,0,1] neg_hi:[0,0,1]
    v_pk_fma_f32 v[214:215], v[214:215], v[160:161], v[160:161] op_sel:[0,1,0] op_sel_hi:[1,1,0] neg_lo:[0,0,1] neg_hi:[0,0,1]
    v_pk_fma_f32 v[216:217], v[216:217], v[160:161], v[160:161] op_sel:[0,1,0] op_sel_hi:[1,1,0] neg_lo:[0,0,1] neg_hi:[0,0,1]
    v_pk_fma_f32 v[218:219], v[218:219], v[160:161], v[160:161] op_sel:[0,1,0] op_sel_hi:[1,1,0] neg_lo:[0,0,1] neg_hi:[0,0,1]
    v_pk_fma_f32 v[220:221], v[220:221], v[160:161], v[160:161] op_sel:[0,1,0] op_sel_hi:[1,1,0] neg_lo:[0,0,1] neg_hi:[0,0,1]
    v_pk_fma_f32 v[222:223], v[222:223], v[160:161], v[160:161] op_sel:[0,1,0] op_sel_hi:[1,1,0] neg_lo:[0,0,1] neg_hi:[0,0,1]
    v_pk_fma_f32 v[224:225], v[224:225], v[160:161], v[160:161] op_sel:[0,1,0] op_sel_hi:[1,1,0] neg_lo:[0,0,1] neg_hi:[0,0,1]
    v_pk_fma_f32 v[226:227], v[226:227], v[160:161], v[160:161] op_sel:[0,1,0] op_sel_hi:[1,1,0] neg_lo:[0,0,1] neg_hi:[0,0,1]
    v_pk_fma_f32 v[228:229], v[228:229], v[160:161], v[160:161] op_sel:[0,1,0] op_sel_hi:[1,1,0] neg_lo:[0,0,1] neg_hi:[0,0,1]
    v_pk_fma_f32 v[230:231], v[230:231], v[160:161], v[160:161] op_sel:[0,1,0] op_sel_hi:[1,1,0] neg_lo:[0,0,1] neg_hi:[0,0,1]
    v_pk_fma_f32 v[232:233], v[232:233], v[160:161], v[160:161] op_sel:[0,1,0] op_sel_hi:[1,1,0] neg_lo:[0,0,1] neg_hi:[0,0,1]
    v_pk_fma_f32 v[234:235], v[234:235], v[160:161], v[160:161] op_sel:[0,1,0] op_sel_hi:[1,1,0] neg_lo:[0,0,1] neg_hi:[0,0,1]
    v_pk_fma_f32 v[236:237], v[236:237], v[160:161], v[160:161] op_sel:[0,1,0] op_sel_hi:[1,1,0] neg_lo:[0,0,1] neg_hi:[0,0,1]
    v_pk_fma_f32 v[238:239], v[238:239], v[160:161], v[160:161] op_sel:[0,1,0] op_sel_hi:[1,1,0] neg_lo:[0,0,1] neg_hi:[0,0,1]
    v_pk_fma_f32 v[240:241], v[240:241], v[160:161], v[160:161] op_sel:[0,1,0] op_sel_hi:[1,1,0] neg_lo:[0,0,1] neg_hi:[0,0,1]
    v_pk_fma_f32 v[242:243], v[242:243], v[160:161], v[160:161] op_sel:[0,1,0] op_sel_hi:[1,1,0] neg_lo:[0,0,1] neg_hi:[0,0,1]
    v_pk_fma_f32 v[244:245], v[244:245], v[160:161], v[160:161] op_sel:[0,1,0] op_sel_hi:[1,1,0] neg_lo:[0,0,1] neg_hi:[0,0,1]
    v_pk_fma_f32 v[246:247], v[246:247], v[160:161], v[160:161] op_sel:[0,1,0] op_sel_hi:[1,1,0] neg_lo:[0,0,1] neg_hi:[0,0,1]
    s_lshr_b32 s43, s28, 3
    s_mul_i32 s30, s43, 9216
    s_and_b32 s6, s3, 1
    s_lshl_b32 s6, s6, 10
    s_add_u32 s30, s30, s6
    s_bitcmp1_b32 s3, 1
    s_cselect_b32 s6, 1536, 0
    s_add_u32 s30, s30, s6
    s_and_b32 s31, s3, 3
    s_lshl_b32 s31, s31, 10
    s_add_u32 s31, s31, 73728
    s_cmp_lg_u32 s3, 7
    s_cbranch_scc1 L_standalone__dit_block__diffusion_kernel_pdg
    v_mov_b32 v5, 0
    s_mov_b32 s7, 0
L_standalone__dit_block__diffusion_kernel_plg:
    buffer_load_dword v6, v5, s[96:99], 0 offen sc1
    s_waitcnt vmcnt(0)
    v_cmp_eq_u32 vcc, 0, v6
    s_add_u32 s7, s7, 1
    s_cmp_ge_u32 s7, 0x10000
    s_cbranch_scc1 L_standalone__dit_block__diffusion_kernel_pdg
    s_nop 2
    s_cbranch_vccz L_standalone__dit_block__diffusion_kernel_pdg
    s_sleep 3
    s_branch L_standalone__dit_block__diffusion_kernel_plg
L_standalone__dit_block__diffusion_kernel_pdg:
    s_barrier
    s_mov_b32 m0, s31
    s_nop 0
    buffer_load_dwordx4 v4, s[8:11], s30 offen sc1 lds
    v_lshrrev_b32 v168, 2, v2
    v_lshl_add_u32 v168, v3, 3, v168
    v_mul_u32_u24 v168, 192, v168
    v_and_b32 v169, 3, v2
    v_lshl_add_u32 v168, v169, 3, v168
    v_add_u32 v168, 0, v168
    v_and_b32 v170, 1, v3
    v_lshlrev_b32 v170, 5, v170
    v_sub_u32 v169, v168, v170
    v_add_u32 v168, v168, v170
    v_add_u32 v170, 36864, v168
    v_add_u32 v171, 36864, v169
    s_cmp_lt_u32 s29, 4
    s_cselect_b32 s30, 0x3dd53b95, 1.0
    s_cselect_b64 vcc, -1, 0
    s_cselect_b32 s33, -1, -2
    s_and_b32 s33, s42, s33
    s_mul_i32 s33, s33, 12
    s_lshr_b32 s31, s29, 2
    s_mul_i32 s31, s31, 0x180000
    s_and_b32 s32, s29, 3
    s_mul_i32 s32, s32, 3
    s_add_u32 s32, s32, s33
    s_lshl_b32 s32, s32, 10
    s_add_u32 s31, s31, s32
    s_add_u32 s31, s31, 0x600000
    s_and_b32 s34, s3, 1
    v_bfe_u32 v5, v2, 2, 1
    v_mul_u32_u24 v5, 12288, v5
    v_lshl_add_u32 v5, v3, 8, v5
    v_lshrrev_b32 v6, 3, v2
    v_lshl_add_u32 v5, v6, 6, v5
    v_and_b32 v6, 3, v2
    v_lshl_add_u32 v5, v6, 4, v5
    s_lshl_b32 s6, s34, 7
    v_add_u32 v5, s6, v5
    v_cndmask_b32 v5, v5, v4, vcc
    s_lshl_b32 s35, s28, 6
    s_lshl_b32 s6, s29, 2
    s_add_u32 s35, s35, s6
    v_lshlrev_b32 v1, 5, v3
    v_add_u32 v1, 73728, v1
    s_waitcnt vmcnt(0)
    s_barrier
    s_cmp_ge_u32 s29, 8
    s_cbranch_scc1 L_standalone__dit_block__diffusion_kernel_v
    ds_read_b128 v[176:179], v1 offset:0
    ds_read_b128 v[180:183], v1 offset:2048
    ds_read_b128 v[184:187], v1 offset:16
    ds_read_b128 v[188:191], v1 offset:2064
    ds_read_b64_tr_b16 v[128:129], v168 offset:0
    ds_read_b64_tr_b16 v[130:131], v168 offset:768
    ds_read_b64_tr_b16 v[132:133], v169 offset:32
    ds_read_b64_tr_b16 v[134:135], v169 offset:800
    ds_read_b64_tr_b16 v[136:137], v168 offset:64
    ds_read_b64_tr_b16 v[138:139], v168 offset:832
    ds_read_b64_tr_b16 v[140:141], v169 offset:96
    ds_read_b64_tr_b16 v[142:143], v169 offset:864
    s_waitcnt lgkmcnt(10)
    v_fma_f32 v56, v56, v180, v176
    v_fma_f32 v57, v57, v181, v177
    v_fma_f32 v58, v58, v182, v178
    v_fma_f32 v59, v59, v183, v179
    v_cvt_pk_bf16_f32 v8, v56, v57
    v_cvt_pk_bf16_f32 v9, v58, v59
    ds_read_b128 v[176:179], v1 offset:128
    ds_read_b128 v[180:183], v1 offset:2176
    s_waitcnt lgkmcnt(10)
    v_fma_f32 v60, v60, v188, v184
    v_fma_f32 v61, v61, v189, v185
    v_fma_f32 v62, v62, v190, v186
    v_fma_f32 v63, v63, v191, v187
    v_cvt_pk_bf16_f32 v10, v60, v61
    v_cvt_pk_bf16_f32 v11, v62, v63
    ds_read_b128 v[184:187], v1 offset:144
    ds_read_b128 v[188:191], v1 offset:2192
    s_waitcnt lgkmcnt(10)
    v_mfma_f32_16x16x32_bf16 v[104:107], v[128:131], v[8:11], 0
    s_mov_b32 m0, s36
    s_add_u32 s36, s36, 1024
    buffer_load_dwordx4 v172, s[20:23], s37 offen lds
    ds_read_b64_tr_b16 v[144:145], v168 offset:6144
    ds_read_b64_tr_b16 v[146:147], v168 offset:6912
    s_waitcnt lgkmcnt(10)
    v_mfma_f32_16x16x32_bf16 v[108:111], v[132:135], v[8:11], 0
    ds_read_b64_tr_b16 v[148:149], v169 offset:6176
    ds_read_b64_tr_b16 v[150:151], v169 offset:6944
    s_waitcnt lgkmcnt(10)
    v_mfma_f32_16x16x32_bf16 v[112:115], v[136:139], v[8:11], 0
    ds_read_b64_tr_b16 v[152:153], v168 offset:6208
    ds_read_b64_tr_b16 v[154:155], v168 offset:6976
    s_waitcnt lgkmcnt(10)
    v_mfma_f32_16x16x32_bf16 v[116:119], v[140:143], v[8:11], 0
    ds_read_b64_tr_b16 v[156:157], v169 offset:6240
    ds_read_b64_tr_b16 v[158:159], v169 offset:7008
    s_waitcnt lgkmcnt(10)
    v_fma_f32 v64, v64, v180, v176
    v_fma_f32 v65, v65, v181, v177
    v_fma_f32 v66, v66, v182, v178
    v_fma_f32 v67, v67, v183, v179
    v_cvt_pk_bf16_f32 v12, v64, v65
    v_cvt_pk_bf16_f32 v13, v66, v67
    ds_read_b128 v[176:179], v1 offset:256
    ds_read_b128 v[180:183], v1 offset:2304
    s_waitcnt lgkmcnt(10)
    v_fma_f32 v68, v68, v188, v184
    v_fma_f32 v69, v69, v189, v185
    v_fma_f32 v70, v70, v190, v186
    v_fma_f32 v71, v71, v191, v187
    v_cvt_pk_bf16_f32 v14, v68, v69
    v_cvt_pk_bf16_f32 v15, v70, v71
    ds_read_b128 v[184:187], v1 offset:272
    ds_read_b128 v[188:191], v1 offset:2320
    s_waitcnt lgkmcnt(10)
    v_mfma_f32_16x16x32_bf16 v[104:107], v[144:147], v[12:15], v[104:107]
    ds_read_b64_tr_b16 v[128:129], v168 offset:12288
    ds_read_b64_tr_b16 v[130:131], v168 offset:13056
    s_waitcnt lgkmcnt(10)
    v_mfma_f32_16x16x32_bf16 v[108:111], v[148:151], v[12:15], v[108:111]
    s_mov_b32 m0, s36
    s_add_u32 s36, s36, 1024
    buffer_load_dwordx4 v173, s[20:23], s37 offen lds
    ds_read_b64_tr_b16 v[132:133], v169 offset:12320
    ds_read_b64_tr_b16 v[134:135], v169 offset:13088
    s_waitcnt lgkmcnt(10)
    v_mfma_f32_16x16x32_bf16 v[112:115], v[152:155], v[12:15], v[112:115]
    ds_read_b64_tr_b16 v[136:137], v168 offset:12352
    ds_read_b64_tr_b16 v[138:139], v168 offset:13120
    s_waitcnt lgkmcnt(10)
    v_mfma_f32_16x16x32_bf16 v[116:119], v[156:159], v[12:15], v[116:119]
    ds_read_b64_tr_b16 v[140:141], v169 offset:12384
    ds_read_b64_tr_b16 v[142:143], v169 offset:13152
    s_waitcnt lgkmcnt(10)
    v_fma_f32 v72, v72, v180, v176
    v_fma_f32 v73, v73, v181, v177
    v_fma_f32 v74, v74, v182, v178
    v_fma_f32 v75, v75, v183, v179
    v_cvt_pk_bf16_f32 v16, v72, v73
    v_cvt_pk_bf16_f32 v17, v74, v75
    ds_read_b128 v[176:179], v1 offset:384
    ds_read_b128 v[180:183], v1 offset:2432
    s_waitcnt lgkmcnt(10)
    v_fma_f32 v76, v76, v188, v184
    v_fma_f32 v77, v77, v189, v185
    v_fma_f32 v78, v78, v190, v186
    v_fma_f32 v79, v79, v191, v187
    v_cvt_pk_bf16_f32 v18, v76, v77
    v_cvt_pk_bf16_f32 v19, v78, v79
    ds_read_b128 v[184:187], v1 offset:400
    ds_read_b128 v[188:191], v1 offset:2448
    s_waitcnt lgkmcnt(10)
    v_mfma_f32_16x16x32_bf16 v[104:107], v[128:131], v[16:19], v[104:107]
    ds_read_b64_tr_b16 v[144:145], v168 offset:18432
    ds_read_b64_tr_b16 v[146:147], v168 offset:19200
    s_waitcnt lgkmcnt(10)
    v_mfma_f32_16x16x32_bf16 v[108:111], v[132:135], v[16:19], v[108:111]
    ds_read_b64_tr_b16 v[148:149], v169 offset:18464
    ds_read_b64_tr_b16 v[150:151], v169 offset:19232
    s_waitcnt lgkmcnt(10)
    v_mfma_f32_16x16x32_bf16 v[112:115], v[136:139], v[16:19], v[112:115]
    s_mov_b32 m0, s36
    s_add_u32 s36, s36, 1024
    buffer_load_dwordx4 v174, s[20:23], s37 offen lds
    s_add_u32 s37, s37, 12288
    ds_read_b64_tr_b16 v[152:153], v168 offset:18496
    ds_read_b64_tr_b16 v[154:155], v168 offset:19264
    s_waitcnt lgkmcnt(10)
    v_mfma_f32_16x16x32_bf16 v[116:119], v[140:143], v[16:19], v[116:119]
    ds_read_b64_tr_b16 v[156:157], v169 offset:18528
    ds_read_b64_tr_b16 v[158:159], v169 offset:19296
    s_waitcnt lgkmcnt(10)
    v_fma_f32 v80, v80, v180, v176
    v_fma_f32 v81, v81, v181, v177
    v_fma_f32 v82, v82, v182, v178
    v_fma_f32 v83, v83, v183, v179
    v_cvt_pk_bf16_f32 v20, v80, v81
    v_cvt_pk_bf16_f32 v21, v82, v83
    ds_read_b128 v[176:179], v1 offset:512
    ds_read_b128 v[180:183], v1 offset:2560
    s_waitcnt lgkmcnt(10)
    v_fma_f32 v84, v84, v188, v184
    v_fma_f32 v85, v85, v189, v185
    v_fma_f32 v86, v86, v190, v186
    v_fma_f32 v87, v87, v191, v187
    v_cvt_pk_bf16_f32 v22, v84, v85
    v_cvt_pk_bf16_f32 v23, v86, v87
    ds_read_b128 v[184:187], v1 offset:528
    ds_read_b128 v[188:191], v1 offset:2576
    s_waitcnt lgkmcnt(10)
    v_mfma_f32_16x16x32_bf16 v[104:107], v[144:147], v[20:23], v[104:107]
    ds_read_b64_tr_b16 v[128:129], v168 offset:24576
    ds_read_b64_tr_b16 v[130:131], v168 offset:25344
    s_waitcnt lgkmcnt(10)
    v_mfma_f32_16x16x32_bf16 v[108:111], v[148:151], v[20:23], v[108:111]
    ds_read_b64_tr_b16 v[132:133], v169 offset:24608
    ds_read_b64_tr_b16 v[134:135], v169 offset:25376
    s_waitcnt lgkmcnt(10)
    v_mfma_f32_16x16x32_bf16 v[112:115], v[152:155], v[20:23], v[112:115]
    ds_read_b64_tr_b16 v[136:137], v168 offset:24640
    ds_read_b64_tr_b16 v[138:139], v168 offset:25408
    s_waitcnt lgkmcnt(10)
    v_mfma_f32_16x16x32_bf16 v[116:119], v[156:159], v[20:23], v[116:119]
    s_mov_b32 m0, s36
    s_add_u32 s36, s36, 1024
    buffer_load_dwordx4 v172, s[20:23], s37 offen lds
    ds_read_b64_tr_b16 v[140:141], v169 offset:24672
    ds_read_b64_tr_b16 v[142:143], v169 offset:25440
    s_waitcnt lgkmcnt(10)
    v_fma_f32 v88, v88, v180, v176
    v_fma_f32 v89, v89, v181, v177
    v_fma_f32 v90, v90, v182, v178
    v_fma_f32 v91, v91, v183, v179
    v_cvt_pk_bf16_f32 v24, v88, v89
    v_cvt_pk_bf16_f32 v25, v90, v91
    ds_read_b128 v[176:179], v1 offset:640
    ds_read_b128 v[180:183], v1 offset:2688
    s_waitcnt lgkmcnt(10)
    v_fma_f32 v92, v92, v188, v184
    v_fma_f32 v93, v93, v189, v185
    v_fma_f32 v94, v94, v190, v186
    v_fma_f32 v95, v95, v191, v187
    v_cvt_pk_bf16_f32 v26, v92, v93
    v_cvt_pk_bf16_f32 v27, v94, v95
    ds_read_b128 v[184:187], v1 offset:656
    ds_read_b128 v[188:191], v1 offset:2704
    s_waitcnt lgkmcnt(10)
    v_mfma_f32_16x16x32_bf16 v[104:107], v[128:131], v[24:27], v[104:107]
    ds_read_b64_tr_b16 v[144:145], v168 offset:30720
    ds_read_b64_tr_b16 v[146:147], v168 offset:31488
    s_waitcnt lgkmcnt(10)
    v_mfma_f32_16x16x32_bf16 v[108:111], v[132:135], v[24:27], v[108:111]
    ds_read_b64_tr_b16 v[148:149], v169 offset:30752
    ds_read_b64_tr_b16 v[150:151], v169 offset:31520
    s_waitcnt lgkmcnt(10)
    v_mfma_f32_16x16x32_bf16 v[112:115], v[136:139], v[24:27], v[112:115]
    ds_read_b64_tr_b16 v[152:153], v168 offset:30784
    ds_read_b64_tr_b16 v[154:155], v168 offset:31552
    s_waitcnt lgkmcnt(10)
    v_mfma_f32_16x16x32_bf16 v[116:119], v[140:143], v[24:27], v[116:119]
    ds_read_b64_tr_b16 v[156:157], v169 offset:30816
    ds_read_b64_tr_b16 v[158:159], v169 offset:31584
    s_waitcnt lgkmcnt(10)
    v_fma_f32 v96, v96, v180, v176
    v_fma_f32 v97, v97, v181, v177
    v_fma_f32 v98, v98, v182, v178
    v_fma_f32 v99, v99, v183, v179
    v_cvt_pk_bf16_f32 v28, v96, v97
    v_cvt_pk_bf16_f32 v29, v98, v99
    ds_read_b128 v[176:179], v1 offset:768
    ds_read_b128 v[180:183], v1 offset:2816
    s_waitcnt lgkmcnt(10)
    v_fma_f32 v100, v100, v188, v184
    v_fma_f32 v101, v101, v189, v185
    v_fma_f32 v102, v102, v190, v186
    v_fma_f32 v103, v103, v191, v187
    v_cvt_pk_bf16_f32 v30, v100, v101
    v_cvt_pk_bf16_f32 v31, v102, v103
    ds_read_b128 v[184:187], v1 offset:784
    ds_read_b128 v[188:191], v1 offset:2832
    s_waitcnt lgkmcnt(10)
    v_mfma_f32_16x16x32_bf16 v[104:107], v[144:147], v[28:31], v[104:107]
    s_mov_b32 m0, s36
    s_add_u32 s36, s36, 1024
    buffer_load_dwordx4 v173, s[20:23], s37 offen lds
    ds_read_b64_tr_b16 v[128:129], v170 offset:0
    ds_read_b64_tr_b16 v[130:131], v170 offset:768
    s_waitcnt lgkmcnt(10)
    v_mfma_f32_16x16x32_bf16 v[108:111], v[148:151], v[28:31], v[108:111]
    ds_read_b64_tr_b16 v[132:133], v171 offset:32
    ds_read_b64_tr_b16 v[134:135], v171 offset:800
    s_waitcnt lgkmcnt(10)
    v_mfma_f32_16x16x32_bf16 v[112:115], v[152:155], v[28:31], v[112:115]
    ds_read_b64_tr_b16 v[136:137], v170 offset:64
    ds_read_b64_tr_b16 v[138:139], v170 offset:832
    s_waitcnt lgkmcnt(10)
    v_mfma_f32_16x16x32_bf16 v[116:119], v[156:159], v[28:31], v[116:119]
    ds_read_b64_tr_b16 v[140:141], v171 offset:96
    ds_read_b64_tr_b16 v[142:143], v171 offset:864
    s_waitcnt lgkmcnt(10)
    v_fma_f32 v200, v200, v180, v176
    v_fma_f32 v201, v201, v181, v177
    v_fma_f32 v202, v202, v182, v178
    v_fma_f32 v203, v203, v183, v179
    v_cvt_pk_bf16_f32 v32, v200, v201
    v_cvt_pk_bf16_f32 v33, v202, v203
    ds_read_b128 v[176:179], v1 offset:896
    ds_read_b128 v[180:183], v1 offset:2944
    s_waitcnt lgkmcnt(10)
    v_fma_f32 v204, v204, v188, v184
    v_fma_f32 v205, v205, v189, v185
    v_fma_f32 v206, v206, v190, v186
    v_fma_f32 v207, v207, v191, v187
    v_cvt_pk_bf16_f32 v34, v204, v205
    v_cvt_pk_bf16_f32 v35, v206, v207
    ds_read_b128 v[184:187], v1 offset:912
    ds_read_b128 v[188:191], v1 offset:2960
    s_waitcnt lgkmcnt(10)
    v_mfma_f32_16x16x32_bf16 v[104:107], v[128:131], v[32:35], v[104:107]
    ds_read_b64_tr_b16 v[144:145], v170 offset:6144
    ds_read_b64_tr_b16 v[146:147], v170 offset:6912
    s_waitcnt lgkmcnt(10)
    v_mfma_f32_16x16x32_bf16 v[108:111], v[132:135], v[32:35], v[108:111]
    s_mov_b32 m0, s36
    s_add_u32 s36, s36, 1024
    buffer_load_dwordx4 v174, s[20:23], s37 offen lds
    s_add_u32 s37, s37, 12288
    ds_read_b64_tr_b16 v[148:149], v171 offset:6176
    ds_read_b64_tr_b16 v[150:151], v171 offset:6944
    s_waitcnt lgkmcnt(10)
    v_mfma_f32_16x16x32_bf16 v[112:115], v[136:139], v[32:35], v[112:115]
    ds_read_b64_tr_b16 v[152:153], v170 offset:6208
    ds_read_b64_tr_b16 v[154:155], v170 offset:6976
    s_waitcnt lgkmcnt(10)
    v_mfma_f32_16x16x32_bf16 v[116:119], v[140:143], v[32:35], v[116:119]
    ds_read_b64_tr_b16 v[156:157], v171 offset:6240
    ds_read_b64_tr_b16 v[158:159], v171 offset:7008
    s_waitcnt lgkmcnt(10)
    v_fma_f32 v208, v208, v180, v176
    v_fma_f32 v209, v209, v181, v177
    v_fma_f32 v210, v210, v182, v178
    v_fma_f32 v211, v211, v183, v179
    v_cvt_pk_bf16_f32 v36, v208, v209
    v_cvt_pk_bf16_f32 v37, v210, v211
    ds_read_b128 v[176:179], v1 offset:1024
    ds_read_b128 v[180:183], v1 offset:3072
    s_waitcnt lgkmcnt(10)
    v_fma_f32 v212, v212, v188, v184
    v_fma_f32 v213, v213, v189, v185
    v_fma_f32 v214, v214, v190, v186
    v_fma_f32 v215, v215, v191, v187
    v_cvt_pk_bf16_f32 v38, v212, v213
    v_cvt_pk_bf16_f32 v39, v214, v215
    ds_read_b128 v[184:187], v1 offset:1040
    ds_read_b128 v[188:191], v1 offset:3088
    s_waitcnt lgkmcnt(10)
    v_mfma_f32_16x16x32_bf16 v[104:107], v[144:147], v[36:39], v[104:107]
    ds_read_b64_tr_b16 v[128:129], v170 offset:12288
    ds_read_b64_tr_b16 v[130:131], v170 offset:13056
    s_waitcnt lgkmcnt(10)
    v_mfma_f32_16x16x32_bf16 v[108:111], v[148:151], v[36:39], v[108:111]
    ds_read_b64_tr_b16 v[132:133], v171 offset:12320
    ds_read_b64_tr_b16 v[134:135], v171 offset:13088
    s_waitcnt lgkmcnt(10)
    v_mfma_f32_16x16x32_bf16 v[112:115], v[152:155], v[36:39], v[112:115]
    s_mov_b32 m0, s36
    s_add_u32 s36, s36, 1024
    buffer_load_dwordx4 v172, s[20:23], s37 offen lds
    ds_read_b64_tr_b16 v[136:137], v170 offset:12352
    ds_read_b64_tr_b16 v[138:139], v170 offset:13120
    s_waitcnt lgkmcnt(10)
    v_mfma_f32_16x16x32_bf16 v[116:119], v[156:159], v[36:39], v[116:119]
    ds_read_b64_tr_b16 v[140:141], v171 offset:12384
    ds_read_b64_tr_b16 v[142:143], v171 offset:13152
    s_waitcnt lgkmcnt(10)
    v_fma_f32 v216, v216, v180, v176
    v_fma_f32 v217, v217, v181, v177
    v_fma_f32 v218, v218, v182, v178
    v_fma_f32 v219, v219, v183, v179
    v_cvt_pk_bf16_f32 v40, v216, v217
    v_cvt_pk_bf16_f32 v41, v218, v219
    ds_read_b128 v[176:179], v1 offset:1152
    ds_read_b128 v[180:183], v1 offset:3200
    s_waitcnt lgkmcnt(10)
    v_fma_f32 v220, v220, v188, v184
    v_fma_f32 v221, v221, v189, v185
    v_fma_f32 v222, v222, v190, v186
    v_fma_f32 v223, v223, v191, v187
    v_cvt_pk_bf16_f32 v42, v220, v221
    v_cvt_pk_bf16_f32 v43, v222, v223
    ds_read_b128 v[184:187], v1 offset:1168
    ds_read_b128 v[188:191], v1 offset:3216
    s_waitcnt lgkmcnt(10)
    v_mfma_f32_16x16x32_bf16 v[104:107], v[128:131], v[40:43], v[104:107]
    ds_read_b64_tr_b16 v[144:145], v170 offset:18432
    ds_read_b64_tr_b16 v[146:147], v170 offset:19200
    s_waitcnt lgkmcnt(10)
    v_mfma_f32_16x16x32_bf16 v[108:111], v[132:135], v[40:43], v[108:111]
    ds_read_b64_tr_b16 v[148:149], v171 offset:18464
    ds_read_b64_tr_b16 v[150:151], v171 offset:19232
    s_waitcnt lgkmcnt(10)
    v_mfma_f32_16x16x32_bf16 v[112:115], v[136:139], v[40:43], v[112:115]
    ds_read_b64_tr_b16 v[152:153], v170 offset:18496
    ds_read_b64_tr_b16 v[154:155], v170 offset:19264
    s_waitcnt lgkmcnt(10)
    v_mfma_f32_16x16x32_bf16 v[116:119], v[140:143], v[40:43], v[116:119]
    s_mov_b32 m0, s36
    s_add_u32 s36, s36, 1024
    buffer_load_dwordx4 v173, s[20:23], s37 offen lds
    ds_read_b64_tr_b16 v[156:157], v171 offset:18528
    ds_read_b64_tr_b16 v[158:159], v171 offset:19296
    s_waitcnt lgkmcnt(10)
    v_fma_f32 v224, v224, v180, v176
    v_fma_f32 v225, v225, v181, v177
    v_fma_f32 v226, v226, v182, v178
    v_fma_f32 v227, v227, v183, v179
    v_cvt_pk_bf16_f32 v44, v224, v225
    v_cvt_pk_bf16_f32 v45, v226, v227
    ds_read_b128 v[176:179], v1 offset:1280
    ds_read_b128 v[180:183], v1 offset:3328
    s_waitcnt lgkmcnt(10)
    v_fma_f32 v228, v228, v188, v184
    v_fma_f32 v229, v229, v189, v185
    v_fma_f32 v230, v230, v190, v186
    v_fma_f32 v231, v231, v191, v187
    v_cvt_pk_bf16_f32 v46, v228, v229
    v_cvt_pk_bf16_f32 v47, v230, v231
    ds_read_b128 v[184:187], v1 offset:1296
    ds_read_b128 v[188:191], v1 offset:3344
    s_waitcnt lgkmcnt(10)
    v_mfma_f32_16x16x32_bf16 v[104:107], v[144:147], v[44:47], v[104:107]
    ds_read_b64_tr_b16 v[128:129], v170 offset:24576
    ds_read_b64_tr_b16 v[130:131], v170 offset:25344
    s_waitcnt lgkmcnt(10)
    v_mfma_f32_16x16x32_bf16 v[108:111], v[148:151], v[44:47], v[108:111]
    ds_read_b64_tr_b16 v[132:133], v171 offset:24608
    ds_read_b64_tr_b16 v[134:135], v171 offset:25376
    s_waitcnt lgkmcnt(10)
    v_mfma_f32_16x16x32_bf16 v[112:115], v[152:155], v[44:47], v[112:115]
    ds_read_b64_tr_b16 v[136:137], v170 offset:24640
    ds_read_b64_tr_b16 v[138:139], v170 offset:25408
    s_waitcnt lgkmcnt(10)
    v_mfma_f32_16x16x32_bf16 v[116:119], v[156:159], v[44:47], v[116:119]
    ds_read_b64_tr_b16 v[140:141], v171 offset:24672
    ds_read_b64_tr_b16 v[142:143], v171 offset:25440
    s_waitcnt lgkmcnt(10)
    v_fma_f32 v232, v232, v180, v176
    v_fma_f32 v233, v233, v181, v177
    v_fma_f32 v234, v234, v182, v178
    v_fma_f32 v235, v235, v183, v179
    v_cvt_pk_bf16_f32 v48, v232, v233
    v_cvt_pk_bf16_f32 v49, v234, v235
    ds_read_b128 v[176:179], v1 offset:1408
    ds_read_b128 v[180:183], v1 offset:3456
    s_waitcnt lgkmcnt(10)
    v_fma_f32 v236, v236, v188, v184
    v_fma_f32 v237, v237, v189, v185
    v_fma_f32 v238, v238, v190, v186
    v_fma_f32 v239, v239, v191, v187
    v_cvt_pk_bf16_f32 v50, v236, v237
    v_cvt_pk_bf16_f32 v51, v238, v239
    ds_read_b128 v[184:187], v1 offset:1424
    ds_read_b128 v[188:191], v1 offset:3472
    s_waitcnt lgkmcnt(10)
    v_mfma_f32_16x16x32_bf16 v[104:107], v[128:131], v[48:51], v[104:107]
    s_mov_b32 m0, s36
    s_add_u32 s36, s36, 1024
    buffer_load_dwordx4 v174, s[20:23], s37 offen lds
    s_add_u32 s37, s37, 12288
    ds_read_b64_tr_b16 v[144:145], v170 offset:30720
    ds_read_b64_tr_b16 v[146:147], v170 offset:31488
    s_waitcnt lgkmcnt(10)
    v_mfma_f32_16x16x32_bf16 v[108:111], v[132:135], v[48:51], v[108:111]
    ds_read_b64_tr_b16 v[148:149], v171 offset:30752
    ds_read_b64_tr_b16 v[150:151], v171 offset:31520
    s_waitcnt lgkmcnt(10)
    v_mfma_f32_16x16x32_bf16 v[112:115], v[136:139], v[48:51], v[112:115]
    ds_read_b64_tr_b16 v[152:153], v170 offset:30784
    ds_read_b64_tr_b16 v[154:155], v170 offset:31552
    s_waitcnt lgkmcnt(10)
    v_mfma_f32_16x16x32_bf16 v[116:119], v[140:143], v[48:51], v[116:119]
    ds_read_b64_tr_b16 v[156:157], v171 offset:30816
    ds_read_b64_tr_b16 v[158:159], v171 offset:31584
    s_waitcnt lgkmcnt(10)
    v_fma_f32 v240, v240, v180, v176
    v_fma_f32 v241, v241, v181, v177
    v_fma_f32 v242, v242, v182, v178
    v_fma_f32 v243, v243, v183, v179
    v_cvt_pk_bf16_f32 v52, v240, v241
    v_cvt_pk_bf16_f32 v53, v242, v243
    ds_read_b64_tr_b16 v[128:129], v168 offset:128
    ds_read_b64_tr_b16 v[130:131], v168 offset:896
    s_waitcnt lgkmcnt(10)
    v_fma_f32 v244, v244, v188, v184
    v_fma_f32 v245, v245, v189, v185
    v_fma_f32 v246, v246, v190, v186
    v_fma_f32 v247, v247, v191, v187
    v_cvt_pk_bf16_f32 v54, v244, v245
    v_cvt_pk_bf16_f32 v55, v246, v247
    ds_read_b64_tr_b16 v[132:133], v169 offset:160
    ds_read_b64_tr_b16 v[134:135], v169 offset:928
    s_waitcnt lgkmcnt(10)
    v_mfma_f32_16x16x32_bf16 v[104:107], v[144:147], v[52:55], v[104:107]
    ds_read_b64_tr_b16 v[136:137], v168 offset:6272
    ds_read_b64_tr_b16 v[138:139], v168 offset:7040
    s_waitcnt lgkmcnt(10)
    v_mfma_f32_16x16x32_bf16 v[108:111], v[148:151], v[52:55], v[108:111]
    ds_read_b64_tr_b16 v[140:141], v169 offset:6304
    ds_read_b64_tr_b16 v[142:143], v169 offset:7072
    s_waitcnt lgkmcnt(10)
    v_mfma_f32_16x16x32_bf16 v[112:115], v[152:155], v[52:55], v[112:115]
    ds_read_b64_tr_b16 v[144:145], v168 offset:12416
    ds_read_b64_tr_b16 v[146:147], v168 offset:13184
    s_waitcnt lgkmcnt(10)
    v_mfma_f32_16x16x32_bf16 v[116:119], v[156:159], v[52:55], v[116:119]
    ds_read_b64_tr_b16 v[148:149], v169 offset:12448
    ds_read_b64_tr_b16 v[150:151], v169 offset:13216
    s_waitcnt lgkmcnt(10)
    v_mfma_f32_16x16x32_bf16 v[120:123], v[128:131], v[8:11], 0
    ds_read_b64_tr_b16 v[152:153], v168 offset:18560
    ds_read_b64_tr_b16 v[154:155], v168 offset:19328
    s_waitcnt lgkmcnt(10)
    v_mfma_f32_16x16x32_bf16 v[124:127], v[132:135], v[8:11], 0
    ds_read_b64_tr_b16 v[156:157], v169 offset:18592
    ds_read_b64_tr_b16 v[158:159], v169 offset:19360
    s_waitcnt lgkmcnt(10)
    v_mfma_f32_16x16x32_bf16 v[120:123], v[136:139], v[12:15], v[120:123]
    ds_read_b64_tr_b16 v[128:129], v168 offset:24704
    ds_read_b64_tr_b16 v[130:131], v168 offset:25472
    s_waitcnt lgkmcnt(10)
    v_mfma_f32_16x16x32_bf16 v[124:127], v[140:143], v[12:15], v[124:127]
    ds_read_b64_tr_b16 v[132:133], v169 offset:24736
    ds_read_b64_tr_b16 v[134:135], v169 offset:25504
    s_waitcnt lgkmcnt(10)
    v_mfma_f32_16x16x32_bf16 v[120:123], v[144:147], v[16:19], v[120:123]
    v_mul_f32 v104, s30, v104
    v_mul_f32 v105, s30, v105
    v_mul_f32 v106, s30, v106
    v_mul_f32 v107, s30, v107
    v_mul_f32 v108, s30, v108
    v_mul_f32 v109, s30, v109
    v_mul_f32 v110, s30, v110
    v_mul_f32 v111, s30, v111
    v_cvt_pk_bf16_f32 v160, v104, v105
    v_cvt_pk_bf16_f32 v161, v106, v107
    v_cvt_pk_bf16_f32 v162, v108, v109
    v_cvt_pk_bf16_f32 v163, v110, v111
    buffer_store_dwordx4 v[160:163], v5, s[8:11], s31 offen sc1
    ds_read_b64_tr_b16 v[136:137], v168 offset:30848
    ds_read_b64_tr_b16 v[138:139], v168 offset:31616
    s_waitcnt lgkmcnt(10)
    v_mfma_f32_16x16x32_bf16 v[124:127], v[148:151], v[16:19], v[124:127]
    ds_read_b64_tr_b16 v[140:141], v169 offset:30880
    ds_read_b64_tr_b16 v[142:143], v169 offset:31648
    s_waitcnt lgkmcnt(10)
    v_mfma_f32_16x16x32_bf16 v[120:123], v[152:155], v[20:23], v[120:123]
    ds_read_b64_tr_b16 v[144:145], v170 offset:128
    ds_read_b64_tr_b16 v[146:147], v170 offset:896
    s_waitcnt lgkmcnt(10)
    v_mfma_f32_16x16x32_bf16 v[124:127], v[156:159], v[20:23], v[124:127]
    ds_read_b64_tr_b16 v[148:149], v171 offset:160
    ds_read_b64_tr_b16 v[150:151], v171 offset:928
    s_waitcnt lgkmcnt(10)
    v_mfma_f32_16x16x32_bf16 v[120:123], v[128:131], v[24:27], v[120:123]
    ds_read_b64_tr_b16 v[152:153], v170 offset:6272
    ds_read_b64_tr_b16 v[154:155], v170 offset:7040
    s_waitcnt lgkmcnt(10)
    v_mfma_f32_16x16x32_bf16 v[124:127], v[132:135], v[24:27], v[124:127]
    ds_read_b64_tr_b16 v[156:157], v171 offset:6304
    ds_read_b64_tr_b16 v[158:159], v171 offset:7072
    s_waitcnt lgkmcnt(10)
    v_mfma_f32_16x16x32_bf16 v[120:123], v[136:139], v[28:31], v[120:123]
    ds_read_b64_tr_b16 v[128:129], v170 offset:12416
    ds_read_b64_tr_b16 v[130:131], v170 offset:13184
    s_waitcnt lgkmcnt(10)
    v_mfma_f32_16x16x32_bf16 v[124:127], v[140:143], v[28:31], v[124:127]
    ds_read_b64_tr_b16 v[132:133], v171 offset:12448
    ds_read_b64_tr_b16 v[134:135], v171 offset:13216
    s_waitcnt lgkmcnt(10)
    v_mfma_f32_16x16x32_bf16 v[120:123], v[144:147], v[32:35], v[120:123]
    v_mul_f32 v112, s30, v112
    v_mul_f32 v113, s30, v113
    v_mul_f32 v114, s30, v114
    v_mul_f32 v115, s30, v115
    v_mul_f32 v116, s30, v116
    v_mul_f32 v117, s30, v117
    v_mul_f32 v118, s30, v118
    v_mul_f32 v119, s30, v119
    v_cvt_pk_bf16_f32 v164, v112, v113
    v_cvt_pk_bf16_f32 v165, v114, v115
    v_cvt_pk_bf16_f32 v166, v116, v117
    v_cvt_pk_bf16_f32 v167, v118, v119
    buffer_store_dwordx4 v[164:167], v5, s[8:11], s31 offen offset:1024 sc1
    ds_read_b64_tr_b16 v[136:137], v170 offset:18560
    ds_read_b64_tr_b16 v[138:139], v170 offset:19328
    s_waitcnt lgkmcnt(10)
    v_mfma_f32_16x16x32_bf16 v[124:127], v[148:151], v[32:35], v[124:127]
    ds_read_b64_tr_b16 v[140:141], v171 offset:18592
    ds_read_b64_tr_b16 v[142:143], v171 offset:19360
    s_waitcnt lgkmcnt(10)
    v_mfma_f32_16x16x32_bf16 v[120:123], v[152:155], v[36:39], v[120:123]
    ds_read_b64_tr_b16 v[144:145], v170 offset:24704
    ds_read_b64_tr_b16 v[146:147], v170 offset:25472
    s_waitcnt lgkmcnt(10)
    v_mfma_f32_16x16x32_bf16 v[124:127], v[156:159], v[36:39], v[124:127]
    ds_read_b64_tr_b16 v[148:149], v171 offset:24736
    ds_read_b64_tr_b16 v[150:151], v171 offset:25504
    s_waitcnt lgkmcnt(10)
    v_mfma_f32_16x16x32_bf16 v[120:123], v[128:131], v[40:43], v[120:123]
    ds_read_b64_tr_b16 v[152:153], v170 offset:30848
    ds_read_b64_tr_b16 v[154:155], v170 offset:31616
    s_waitcnt lgkmcnt(10)
    v_mfma_f32_16x16x32_bf16 v[124:127], v[132:135], v[40:43], v[124:127]
    ds_read_b64_tr_b16 v[156:157], v171 offset:30880
    ds_read_b64_tr_b16 v[158:159], v171 offset:31648
    s_waitcnt lgkmcnt(10)
    v_mfma_f32_16x16x32_bf16 v[120:123], v[136:139], v[44:47], v[120:123]
    s_waitcnt lgkmcnt(8)
    v_mfma_f32_16x16x32_bf16 v[124:127], v[140:143], v[44:47], v[124:127]
    s_waitcnt lgkmcnt(6)
    v_mfma_f32_16x16x32_bf16 v[120:123], v[144:147], v[48:51], v[120:123]
    s_waitcnt lgkmcnt(4)
    v_mfma_f32_16x16x32_bf16 v[124:127], v[148:151], v[48:51], v[124:127]
    s_waitcnt lgkmcnt(2)
    v_mfma_f32_16x16x32_bf16 v[120:123], v[152:155], v[52:55], v[120:123]
    s_waitcnt lgkmcnt(0)
    v_mfma_f32_16x16x32_bf16 v[124:127], v[156:159], v[52:55], v[124:127]
    s_nop 7
    v_mul_f32 v120, s30, v120
    v_mul_f32 v121, s30, v121
    v_mul_f32 v122, s30, v122
    v_mul_f32 v123, s30, v123
    v_mul_f32 v124, s30, v124
    v_mul_f32 v125, s30, v125
    v_mul_f32 v126, s30, v126
    v_mul_f32 v127, s30, v127
    v_cvt_pk_bf16_f32 v160, v120, v121
    v_cvt_pk_bf16_f32 v161, v122, v123
    v_cvt_pk_bf16_f32 v162, v124, v125
    v_cvt_pk_bf16_f32 v163, v126, v127
    buffer_store_dwordx4 v[160:163], v5, s[8:11], s31 offen offset:2048 sc1
    v_lshrrev_b32 v1, 6, v0
    s_branch L_standalone__dit_block__diffusion_kernel_p1e
L_standalone__dit_block__diffusion_kernel_v:
    s_sub_u32 s31, s29, 8
    s_mul_i32 s31, s31, 6
    s_mul_i32 s32, s43, 24
    s_add_u32 s31, s31, s32
    s_lshl_b32 s31, s31, 5
    s_and_b32 s32, s42, 63
    s_lshr_b32 s32, s32, 1
    s_add_u32 s31, s31, s32
    s_lshl_b32 s31, s31, 10
    s_lshl_b32 s32, s34, 9
    s_add_u32 s31, s31, s32
    s_add_u32 s31, s31, 0x900000
    v_and_b32 v5, 1, v3
    v_lshlrev_b32 v5, 15, v5
    v_lshrrev_b32 v6, 1, v3
    v_lshl_add_u32 v5, v6, 8, v5
    v_lshl_add_u32 v5, v2, 4, v5
    ds_read_b128 v[176:179], v1 offset:0
    ds_read_b128 v[180:183], v1 offset:2048
    ds_read_b128 v[184:187], v1 offset:16
    ds_read_b128 v[188:191], v1 offset:2064
    ds_read_b64_tr_b16 v[128:129], v168 offset:0
    ds_read_b64_tr_b16 v[130:131], v168 offset:768
    ds_read_b64_tr_b16 v[132:133], v169 offset:32
    ds_read_b64_tr_b16 v[134:135], v169 offset:800
    ds_read_b64_tr_b16 v[136:137], v168 offset:64
    ds_read_b64_tr_b16 v[138:139], v168 offset:832
    ds_read_b64_tr_b16 v[140:141], v169 offset:96
    ds_read_b64_tr_b16 v[142:143], v169 offset:864
    s_waitcnt lgkmcnt(10)
    v_fma_f32 v56, v56, v180, v176
    v_fma_f32 v57, v57, v181, v177
    v_fma_f32 v58, v58, v182, v178
    v_fma_f32 v59, v59, v183, v179
    v_cvt_pk_bf16_f32 v8, v56, v57
    v_cvt_pk_bf16_f32 v9, v58, v59
    ds_read_b128 v[176:179], v1 offset:128
    ds_read_b128 v[180:183], v1 offset:2176
    s_waitcnt lgkmcnt(10)
    v_fma_f32 v60, v60, v188, v184
    v_fma_f32 v61, v61, v189, v185
    v_fma_f32 v62, v62, v190, v186
    v_fma_f32 v63, v63, v191, v187
    v_cvt_pk_bf16_f32 v10, v60, v61
    v_cvt_pk_bf16_f32 v11, v62, v63
    ds_read_b128 v[184:187], v1 offset:144
    ds_read_b128 v[188:191], v1 offset:2192
    s_waitcnt lgkmcnt(10)
    v_mfma_f32_16x16x32_bf16 v[104:107], v[8:11], v[128:131], 0
    s_mov_b32 m0, s36
    s_add_u32 s36, s36, 1024
    buffer_load_dwordx4 v172, s[20:23], s37 offen lds
    ds_read_b64_tr_b16 v[144:145], v168 offset:6144
    ds_read_b64_tr_b16 v[146:147], v168 offset:6912
    s_waitcnt lgkmcnt(10)
    v_mfma_f32_16x16x32_bf16 v[108:111], v[8:11], v[132:135], 0
    ds_read_b64_tr_b16 v[148:149], v169 offset:6176
    ds_read_b64_tr_b16 v[150:151], v169 offset:6944
    s_waitcnt lgkmcnt(10)
    v_mfma_f32_16x16x32_bf16 v[112:115], v[8:11], v[136:139], 0
    ds_read_b64_tr_b16 v[152:153], v168 offset:6208
    ds_read_b64_tr_b16 v[154:155], v168 offset:6976
    s_waitcnt lgkmcnt(10)
    v_mfma_f32_16x16x32_bf16 v[116:119], v[8:11], v[140:143], 0
    ds_read_b64_tr_b16 v[156:157], v169 offset:6240
    ds_read_b64_tr_b16 v[158:159], v169 offset:7008
    s_waitcnt lgkmcnt(10)
    v_fma_f32 v64, v64, v180, v176
    v_fma_f32 v65, v65, v181, v177
    v_fma_f32 v66, v66, v182, v178
    v_fma_f32 v67, v67, v183, v179
    v_cvt_pk_bf16_f32 v12, v64, v65
    v_cvt_pk_bf16_f32 v13, v66, v67
    ds_read_b128 v[176:179], v1 offset:256
    ds_read_b128 v[180:183], v1 offset:2304
    s_waitcnt lgkmcnt(10)
    v_fma_f32 v68, v68, v188, v184
    v_fma_f32 v69, v69, v189, v185
    v_fma_f32 v70, v70, v190, v186
    v_fma_f32 v71, v71, v191, v187
    v_cvt_pk_bf16_f32 v14, v68, v69
    v_cvt_pk_bf16_f32 v15, v70, v71
    ds_read_b128 v[184:187], v1 offset:272
    ds_read_b128 v[188:191], v1 offset:2320
    s_waitcnt lgkmcnt(10)
    v_mfma_f32_16x16x32_bf16 v[104:107], v[12:15], v[144:147], v[104:107]
    ds_read_b64_tr_b16 v[128:129], v168 offset:12288
    ds_read_b64_tr_b16 v[130:131], v168 offset:13056
    s_waitcnt lgkmcnt(10)
    v_mfma_f32_16x16x32_bf16 v[108:111], v[12:15], v[148:151], v[108:111]
    s_mov_b32 m0, s36
    s_add_u32 s36, s36, 1024
    buffer_load_dwordx4 v173, s[20:23], s37 offen lds
    ds_read_b64_tr_b16 v[132:133], v169 offset:12320
    ds_read_b64_tr_b16 v[134:135], v169 offset:13088
    s_waitcnt lgkmcnt(10)
    v_mfma_f32_16x16x32_bf16 v[112:115], v[12:15], v[152:155], v[112:115]
    ds_read_b64_tr_b16 v[136:137], v168 offset:12352
    ds_read_b64_tr_b16 v[138:139], v168 offset:13120
    s_waitcnt lgkmcnt(10)
    v_mfma_f32_16x16x32_bf16 v[116:119], v[12:15], v[156:159], v[116:119]
    ds_read_b64_tr_b16 v[140:141], v169 offset:12384
    ds_read_b64_tr_b16 v[142:143], v169 offset:13152
    s_waitcnt lgkmcnt(10)
    v_fma_f32 v72, v72, v180, v176
    v_fma_f32 v73, v73, v181, v177
    v_fma_f32 v74, v74, v182, v178
    v_fma_f32 v75, v75, v183, v179
    v_cvt_pk_bf16_f32 v16, v72, v73
    v_cvt_pk_bf16_f32 v17, v74, v75
    ds_read_b128 v[176:179], v1 offset:384
    ds_read_b128 v[180:183], v1 offset:2432
    s_waitcnt lgkmcnt(10)
    v_fma_f32 v76, v76, v188, v184
    v_fma_f32 v77, v77, v189, v185
    v_fma_f32 v78, v78, v190, v186
    v_fma_f32 v79, v79, v191, v187
    v_cvt_pk_bf16_f32 v18, v76, v77
    v_cvt_pk_bf16_f32 v19, v78, v79
    ds_read_b128 v[184:187], v1 offset:400
    ds_read_b128 v[188:191], v1 offset:2448
    s_waitcnt lgkmcnt(10)
    v_mfma_f32_16x16x32_bf16 v[104:107], v[16:19], v[128:131], v[104:107]
    ds_read_b64_tr_b16 v[144:145], v168 offset:18432
    ds_read_b64_tr_b16 v[146:147], v168 offset:19200
    s_waitcnt lgkmcnt(10)
    v_mfma_f32_16x16x32_bf16 v[108:111], v[16:19], v[132:135], v[108:111]
    ds_read_b64_tr_b16 v[148:149], v169 offset:18464
    ds_read_b64_tr_b16 v[150:151], v169 offset:19232
    s_waitcnt lgkmcnt(10)
    v_mfma_f32_16x16x32_bf16 v[112:115], v[16:19], v[136:139], v[112:115]
    s_mov_b32 m0, s36
    s_add_u32 s36, s36, 1024
    buffer_load_dwordx4 v174, s[20:23], s37 offen lds
    s_add_u32 s37, s37, 12288
    ds_read_b64_tr_b16 v[152:153], v168 offset:18496
    ds_read_b64_tr_b16 v[154:155], v168 offset:19264
    s_waitcnt lgkmcnt(10)
    v_mfma_f32_16x16x32_bf16 v[116:119], v[16:19], v[140:143], v[116:119]
    ds_read_b64_tr_b16 v[156:157], v169 offset:18528
    ds_read_b64_tr_b16 v[158:159], v169 offset:19296
    s_waitcnt lgkmcnt(10)
    v_fma_f32 v80, v80, v180, v176
    v_fma_f32 v81, v81, v181, v177
    v_fma_f32 v82, v82, v182, v178
    v_fma_f32 v83, v83, v183, v179
    v_cvt_pk_bf16_f32 v20, v80, v81
    v_cvt_pk_bf16_f32 v21, v82, v83
    ds_read_b128 v[176:179], v1 offset:512
    ds_read_b128 v[180:183], v1 offset:2560
    s_waitcnt lgkmcnt(10)
    v_fma_f32 v84, v84, v188, v184
    v_fma_f32 v85, v85, v189, v185
    v_fma_f32 v86, v86, v190, v186
    v_fma_f32 v87, v87, v191, v187
    v_cvt_pk_bf16_f32 v22, v84, v85
    v_cvt_pk_bf16_f32 v23, v86, v87
    ds_read_b128 v[184:187], v1 offset:528
    ds_read_b128 v[188:191], v1 offset:2576
    s_waitcnt lgkmcnt(10)
    v_mfma_f32_16x16x32_bf16 v[104:107], v[20:23], v[144:147], v[104:107]
    ds_read_b64_tr_b16 v[128:129], v168 offset:24576
    ds_read_b64_tr_b16 v[130:131], v168 offset:25344
    s_waitcnt lgkmcnt(10)
    v_mfma_f32_16x16x32_bf16 v[108:111], v[20:23], v[148:151], v[108:111]
    ds_read_b64_tr_b16 v[132:133], v169 offset:24608
    ds_read_b64_tr_b16 v[134:135], v169 offset:25376
    s_waitcnt lgkmcnt(10)
    v_mfma_f32_16x16x32_bf16 v[112:115], v[20:23], v[152:155], v[112:115]
    ds_read_b64_tr_b16 v[136:137], v168 offset:24640
    ds_read_b64_tr_b16 v[138:139], v168 offset:25408
    s_waitcnt lgkmcnt(10)
    v_mfma_f32_16x16x32_bf16 v[116:119], v[20:23], v[156:159], v[116:119]
    s_mov_b32 m0, s36
    s_add_u32 s36, s36, 1024
    buffer_load_dwordx4 v172, s[20:23], s37 offen lds
    ds_read_b64_tr_b16 v[140:141], v169 offset:24672
    ds_read_b64_tr_b16 v[142:143], v169 offset:25440
    s_waitcnt lgkmcnt(10)
    v_fma_f32 v88, v88, v180, v176
    v_fma_f32 v89, v89, v181, v177
    v_fma_f32 v90, v90, v182, v178
    v_fma_f32 v91, v91, v183, v179
    v_cvt_pk_bf16_f32 v24, v88, v89
    v_cvt_pk_bf16_f32 v25, v90, v91
    ds_read_b128 v[176:179], v1 offset:640
    ds_read_b128 v[180:183], v1 offset:2688
    s_waitcnt lgkmcnt(10)
    v_fma_f32 v92, v92, v188, v184
    v_fma_f32 v93, v93, v189, v185
    v_fma_f32 v94, v94, v190, v186
    v_fma_f32 v95, v95, v191, v187
    v_cvt_pk_bf16_f32 v26, v92, v93
    v_cvt_pk_bf16_f32 v27, v94, v95
    ds_read_b128 v[184:187], v1 offset:656
    ds_read_b128 v[188:191], v1 offset:2704
    s_waitcnt lgkmcnt(10)
    v_mfma_f32_16x16x32_bf16 v[104:107], v[24:27], v[128:131], v[104:107]
    ds_read_b64_tr_b16 v[144:145], v168 offset:30720
    ds_read_b64_tr_b16 v[146:147], v168 offset:31488
    s_waitcnt lgkmcnt(10)
    v_mfma_f32_16x16x32_bf16 v[108:111], v[24:27], v[132:135], v[108:111]
    ds_read_b64_tr_b16 v[148:149], v169 offset:30752
    ds_read_b64_tr_b16 v[150:151], v169 offset:31520
    s_waitcnt lgkmcnt(10)
    v_mfma_f32_16x16x32_bf16 v[112:115], v[24:27], v[136:139], v[112:115]
    ds_read_b64_tr_b16 v[152:153], v168 offset:30784
    ds_read_b64_tr_b16 v[154:155], v168 offset:31552
    s_waitcnt lgkmcnt(10)
    v_mfma_f32_16x16x32_bf16 v[116:119], v[24:27], v[140:143], v[116:119]
    ds_read_b64_tr_b16 v[156:157], v169 offset:30816
    ds_read_b64_tr_b16 v[158:159], v169 offset:31584
    s_waitcnt lgkmcnt(10)
    v_fma_f32 v96, v96, v180, v176
    v_fma_f32 v97, v97, v181, v177
    v_fma_f32 v98, v98, v182, v178
    v_fma_f32 v99, v99, v183, v179
    v_cvt_pk_bf16_f32 v28, v96, v97
    v_cvt_pk_bf16_f32 v29, v98, v99
    ds_read_b128 v[176:179], v1 offset:768
    ds_read_b128 v[180:183], v1 offset:2816
    s_waitcnt lgkmcnt(10)
    v_fma_f32 v100, v100, v188, v184
    v_fma_f32 v101, v101, v189, v185
    v_fma_f32 v102, v102, v190, v186
    v_fma_f32 v103, v103, v191, v187
    v_cvt_pk_bf16_f32 v30, v100, v101
    v_cvt_pk_bf16_f32 v31, v102, v103
    ds_read_b128 v[184:187], v1 offset:784
    ds_read_b128 v[188:191], v1 offset:2832
    s_waitcnt lgkmcnt(10)
    v_mfma_f32_16x16x32_bf16 v[104:107], v[28:31], v[144:147], v[104:107]
    s_mov_b32 m0, s36
    s_add_u32 s36, s36, 1024
    buffer_load_dwordx4 v173, s[20:23], s37 offen lds
    ds_read_b64_tr_b16 v[128:129], v170 offset:0
    ds_read_b64_tr_b16 v[130:131], v170 offset:768
    s_waitcnt lgkmcnt(10)
    v_mfma_f32_16x16x32_bf16 v[108:111], v[28:31], v[148:151], v[108:111]
    ds_read_b64_tr_b16 v[132:133], v171 offset:32
    ds_read_b64_tr_b16 v[134:135], v171 offset:800
    s_waitcnt lgkmcnt(10)
    v_mfma_f32_16x16x32_bf16 v[112:115], v[28:31], v[152:155], v[112:115]
    ds_read_b64_tr_b16 v[136:137], v170 offset:64
    ds_read_b64_tr_b16 v[138:139], v170 offset:832
    s_waitcnt lgkmcnt(10)
    v_mfma_f32_16x16x32_bf16 v[116:119], v[28:31], v[156:159], v[116:119]
    ds_read_b64_tr_b16 v[140:141], v171 offset:96
    ds_read_b64_tr_b16 v[142:143], v171 offset:864
    s_waitcnt lgkmcnt(10)
    v_fma_f32 v200, v200, v180, v176
    v_fma_f32 v201, v201, v181, v177
    v_fma_f32 v202, v202, v182, v178
    v_fma_f32 v203, v203, v183, v179
    v_cvt_pk_bf16_f32 v32, v200, v201
    v_cvt_pk_bf16_f32 v33, v202, v203
    ds_read_b128 v[176:179], v1 offset:896
    ds_read_b128 v[180:183], v1 offset:2944
    s_waitcnt lgkmcnt(10)
    v_fma_f32 v204, v204, v188, v184
    v_fma_f32 v205, v205, v189, v185
    v_fma_f32 v206, v206, v190, v186
    v_fma_f32 v207, v207, v191, v187
    v_cvt_pk_bf16_f32 v34, v204, v205
    v_cvt_pk_bf16_f32 v35, v206, v207
    ds_read_b128 v[184:187], v1 offset:912
    ds_read_b128 v[188:191], v1 offset:2960
    s_waitcnt lgkmcnt(10)
    v_mfma_f32_16x16x32_bf16 v[104:107], v[32:35], v[128:131], v[104:107]
    ds_read_b64_tr_b16 v[144:145], v170 offset:6144
    ds_read_b64_tr_b16 v[146:147], v170 offset:6912
    s_waitcnt lgkmcnt(10)
    v_mfma_f32_16x16x32_bf16 v[108:111], v[32:35], v[132:135], v[108:111]
    s_mov_b32 m0, s36
    s_add_u32 s36, s36, 1024
    buffer_load_dwordx4 v174, s[20:23], s37 offen lds
    s_add_u32 s37, s37, 12288
    ds_read_b64_tr_b16 v[148:149], v171 offset:6176
    ds_read_b64_tr_b16 v[150:151], v171 offset:6944
    s_waitcnt lgkmcnt(10)
    v_mfma_f32_16x16x32_bf16 v[112:115], v[32:35], v[136:139], v[112:115]
    ds_read_b64_tr_b16 v[152:153], v170 offset:6208
    ds_read_b64_tr_b16 v[154:155], v170 offset:6976
    s_waitcnt lgkmcnt(10)
    v_mfma_f32_16x16x32_bf16 v[116:119], v[32:35], v[140:143], v[116:119]
    ds_read_b64_tr_b16 v[156:157], v171 offset:6240
    ds_read_b64_tr_b16 v[158:159], v171 offset:7008
    s_waitcnt lgkmcnt(10)
    v_fma_f32 v208, v208, v180, v176
    v_fma_f32 v209, v209, v181, v177
    v_fma_f32 v210, v210, v182, v178
    v_fma_f32 v211, v211, v183, v179
    v_cvt_pk_bf16_f32 v36, v208, v209
    v_cvt_pk_bf16_f32 v37, v210, v211
    ds_read_b128 v[176:179], v1 offset:1024
    ds_read_b128 v[180:183], v1 offset:3072
    s_waitcnt lgkmcnt(10)
    v_fma_f32 v212, v212, v188, v184
    v_fma_f32 v213, v213, v189, v185
    v_fma_f32 v214, v214, v190, v186
    v_fma_f32 v215, v215, v191, v187
    v_cvt_pk_bf16_f32 v38, v212, v213
    v_cvt_pk_bf16_f32 v39, v214, v215
    ds_read_b128 v[184:187], v1 offset:1040
    ds_read_b128 v[188:191], v1 offset:3088
    s_waitcnt lgkmcnt(10)
    v_mfma_f32_16x16x32_bf16 v[104:107], v[36:39], v[144:147], v[104:107]
    ds_read_b64_tr_b16 v[128:129], v170 offset:12288
    ds_read_b64_tr_b16 v[130:131], v170 offset:13056
    s_waitcnt lgkmcnt(10)
    v_mfma_f32_16x16x32_bf16 v[108:111], v[36:39], v[148:151], v[108:111]
    ds_read_b64_tr_b16 v[132:133], v171 offset:12320
    ds_read_b64_tr_b16 v[134:135], v171 offset:13088
    s_waitcnt lgkmcnt(10)
    v_mfma_f32_16x16x32_bf16 v[112:115], v[36:39], v[152:155], v[112:115]
    s_mov_b32 m0, s36
    s_add_u32 s36, s36, 1024
    buffer_load_dwordx4 v172, s[20:23], s37 offen lds
    ds_read_b64_tr_b16 v[136:137], v170 offset:12352
    ds_read_b64_tr_b16 v[138:139], v170 offset:13120
    s_waitcnt lgkmcnt(10)
    v_mfma_f32_16x16x32_bf16 v[116:119], v[36:39], v[156:159], v[116:119]
    ds_read_b64_tr_b16 v[140:141], v171 offset:12384
    ds_read_b64_tr_b16 v[142:143], v171 offset:13152
    s_waitcnt lgkmcnt(10)
    v_fma_f32 v216, v216, v180, v176
    v_fma_f32 v217, v217, v181, v177
    v_fma_f32 v218, v218, v182, v178
    v_fma_f32 v219, v219, v183, v179
    v_cvt_pk_bf16_f32 v40, v216, v217
    v_cvt_pk_bf16_f32 v41, v218, v219
    ds_read_b128 v[176:179], v1 offset:1152
    ds_read_b128 v[180:183], v1 offset:3200
    s_waitcnt lgkmcnt(10)
    v_fma_f32 v220, v220, v188, v184
    v_fma_f32 v221, v221, v189, v185
    v_fma_f32 v222, v222, v190, v186
    v_fma_f32 v223, v223, v191, v187
    v_cvt_pk_bf16_f32 v42, v220, v221
    v_cvt_pk_bf16_f32 v43, v222, v223
    ds_read_b128 v[184:187], v1 offset:1168
    ds_read_b128 v[188:191], v1 offset:3216
    s_waitcnt lgkmcnt(10)
    v_mfma_f32_16x16x32_bf16 v[104:107], v[40:43], v[128:131], v[104:107]
    ds_read_b64_tr_b16 v[144:145], v170 offset:18432
    ds_read_b64_tr_b16 v[146:147], v170 offset:19200
    s_waitcnt lgkmcnt(10)
    v_mfma_f32_16x16x32_bf16 v[108:111], v[40:43], v[132:135], v[108:111]
    ds_read_b64_tr_b16 v[148:149], v171 offset:18464
    ds_read_b64_tr_b16 v[150:151], v171 offset:19232
    s_waitcnt lgkmcnt(10)
    v_mfma_f32_16x16x32_bf16 v[112:115], v[40:43], v[136:139], v[112:115]
    ds_read_b64_tr_b16 v[152:153], v170 offset:18496
    ds_read_b64_tr_b16 v[154:155], v170 offset:19264
    s_waitcnt lgkmcnt(10)
    v_mfma_f32_16x16x32_bf16 v[116:119], v[40:43], v[140:143], v[116:119]
    s_mov_b32 m0, s36
    s_add_u32 s36, s36, 1024
    buffer_load_dwordx4 v173, s[20:23], s37 offen lds
    ds_read_b64_tr_b16 v[156:157], v171 offset:18528
    ds_read_b64_tr_b16 v[158:159], v171 offset:19296
    s_waitcnt lgkmcnt(10)
    v_fma_f32 v224, v224, v180, v176
    v_fma_f32 v225, v225, v181, v177
    v_fma_f32 v226, v226, v182, v178
    v_fma_f32 v227, v227, v183, v179
    v_cvt_pk_bf16_f32 v44, v224, v225
    v_cvt_pk_bf16_f32 v45, v226, v227
    ds_read_b128 v[176:179], v1 offset:1280
    ds_read_b128 v[180:183], v1 offset:3328
    s_waitcnt lgkmcnt(10)
    v_fma_f32 v228, v228, v188, v184
    v_fma_f32 v229, v229, v189, v185
    v_fma_f32 v230, v230, v190, v186
    v_fma_f32 v231, v231, v191, v187
    v_cvt_pk_bf16_f32 v46, v228, v229
    v_cvt_pk_bf16_f32 v47, v230, v231
    ds_read_b128 v[184:187], v1 offset:1296
    ds_read_b128 v[188:191], v1 offset:3344
    s_waitcnt lgkmcnt(10)
    v_mfma_f32_16x16x32_bf16 v[104:107], v[44:47], v[144:147], v[104:107]
    ds_read_b64_tr_b16 v[128:129], v170 offset:24576
    ds_read_b64_tr_b16 v[130:131], v170 offset:25344
    s_waitcnt lgkmcnt(10)
    v_mfma_f32_16x16x32_bf16 v[108:111], v[44:47], v[148:151], v[108:111]
    ds_read_b64_tr_b16 v[132:133], v171 offset:24608
    ds_read_b64_tr_b16 v[134:135], v171 offset:25376
    s_waitcnt lgkmcnt(10)
    v_mfma_f32_16x16x32_bf16 v[112:115], v[44:47], v[152:155], v[112:115]
    ds_read_b64_tr_b16 v[136:137], v170 offset:24640
    ds_read_b64_tr_b16 v[138:139], v170 offset:25408
    s_waitcnt lgkmcnt(10)
    v_mfma_f32_16x16x32_bf16 v[116:119], v[44:47], v[156:159], v[116:119]
    ds_read_b64_tr_b16 v[140:141], v171 offset:24672
    ds_read_b64_tr_b16 v[142:143], v171 offset:25440
    s_waitcnt lgkmcnt(10)
    v_fma_f32 v232, v232, v180, v176
    v_fma_f32 v233, v233, v181, v177
    v_fma_f32 v234, v234, v182, v178
    v_fma_f32 v235, v235, v183, v179
    v_cvt_pk_bf16_f32 v48, v232, v233
    v_cvt_pk_bf16_f32 v49, v234, v235
    ds_read_b128 v[176:179], v1 offset:1408
    ds_read_b128 v[180:183], v1 offset:3456
    s_waitcnt lgkmcnt(10)
    v_fma_f32 v236, v236, v188, v184
    v_fma_f32 v237, v237, v189, v185
    v_fma_f32 v238, v238, v190, v186
    v_fma_f32 v239, v239, v191, v187
    v_cvt_pk_bf16_f32 v50, v236, v237
    v_cvt_pk_bf16_f32 v51, v238, v239
    ds_read_b128 v[184:187], v1 offset:1424
    ds_read_b128 v[188:191], v1 offset:3472
    s_waitcnt lgkmcnt(10)
    v_mfma_f32_16x16x32_bf16 v[104:107], v[48:51], v[128:131], v[104:107]
    s_mov_b32 m0, s36
    s_add_u32 s36, s36, 1024
    buffer_load_dwordx4 v174, s[20:23], s37 offen lds
    s_add_u32 s37, s37, 12288
    ds_read_b64_tr_b16 v[144:145], v170 offset:30720
    ds_read_b64_tr_b16 v[146:147], v170 offset:31488
    s_waitcnt lgkmcnt(10)
    v_mfma_f32_16x16x32_bf16 v[108:111], v[48:51], v[132:135], v[108:111]
    ds_read_b64_tr_b16 v[148:149], v171 offset:30752
    ds_read_b64_tr_b16 v[150:151], v171 offset:31520
    s_waitcnt lgkmcnt(10)
    v_mfma_f32_16x16x32_bf16 v[112:115], v[48:51], v[136:139], v[112:115]
    ds_read_b64_tr_b16 v[152:153], v170 offset:30784
    ds_read_b64_tr_b16 v[154:155], v170 offset:31552
    s_waitcnt lgkmcnt(10)
    v_mfma_f32_16x16x32_bf16 v[116:119], v[48:51], v[140:143], v[116:119]
    ds_read_b64_tr_b16 v[156:157], v171 offset:30816
    ds_read_b64_tr_b16 v[158:159], v171 offset:31584
    s_waitcnt lgkmcnt(10)
    v_fma_f32 v240, v240, v180, v176
    v_fma_f32 v241, v241, v181, v177
    v_fma_f32 v242, v242, v182, v178
    v_fma_f32 v243, v243, v183, v179
    v_cvt_pk_bf16_f32 v52, v240, v241
    v_cvt_pk_bf16_f32 v53, v242, v243
    ds_read_b64_tr_b16 v[128:129], v168 offset:128
    ds_read_b64_tr_b16 v[130:131], v168 offset:896
    s_waitcnt lgkmcnt(10)
    v_fma_f32 v244, v244, v188, v184
    v_fma_f32 v245, v245, v189, v185
    v_fma_f32 v246, v246, v190, v186
    v_fma_f32 v247, v247, v191, v187
    v_cvt_pk_bf16_f32 v54, v244, v245
    v_cvt_pk_bf16_f32 v55, v246, v247
    ds_read_b64_tr_b16 v[132:133], v169 offset:160
    ds_read_b64_tr_b16 v[134:135], v169 offset:928
    s_waitcnt lgkmcnt(10)
    v_mfma_f32_16x16x32_bf16 v[104:107], v[52:55], v[144:147], v[104:107]
    ds_read_b64_tr_b16 v[136:137], v168 offset:6272
    ds_read_b64_tr_b16 v[138:139], v168 offset:7040
    s_waitcnt lgkmcnt(10)
    v_mfma_f32_16x16x32_bf16 v[108:111], v[52:55], v[148:151], v[108:111]
    ds_read_b64_tr_b16 v[140:141], v169 offset:6304
    ds_read_b64_tr_b16 v[142:143], v169 offset:7072
    s_waitcnt lgkmcnt(10)
    v_mfma_f32_16x16x32_bf16 v[112:115], v[52:55], v[152:155], v[112:115]
    ds_read_b64_tr_b16 v[144:145], v168 offset:12416
    ds_read_b64_tr_b16 v[146:147], v168 offset:13184
    s_waitcnt lgkmcnt(10)
    v_mfma_f32_16x16x32_bf16 v[116:119], v[52:55], v[156:159], v[116:119]
    ds_read_b64_tr_b16 v[148:149], v169 offset:12448
    ds_read_b64_tr_b16 v[150:151], v169 offset:13216
    s_waitcnt lgkmcnt(10)
    v_mfma_f32_16x16x32_bf16 v[120:123], v[8:11], v[128:131], 0
    ds_read_b64_tr_b16 v[152:153], v168 offset:18560
    ds_read_b64_tr_b16 v[154:155], v168 offset:19328
    s_waitcnt lgkmcnt(10)
    v_mfma_f32_16x16x32_bf16 v[124:127], v[8:11], v[132:135], 0
    ds_read_b64_tr_b16 v[156:157], v169 offset:18592
    ds_read_b64_tr_b16 v[158:159], v169 offset:19360
    s_waitcnt lgkmcnt(10)
    v_mfma_f32_16x16x32_bf16 v[120:123], v[12:15], v[136:139], v[120:123]
    ds_read_b64_tr_b16 v[128:129], v168 offset:24704
    ds_read_b64_tr_b16 v[130:131], v168 offset:25472
    s_waitcnt lgkmcnt(10)
    v_mfma_f32_16x16x32_bf16 v[124:127], v[12:15], v[140:143], v[124:127]
    ds_read_b64_tr_b16 v[132:133], v169 offset:24736
    ds_read_b64_tr_b16 v[134:135], v169 offset:25504
    s_waitcnt lgkmcnt(10)
    v_mfma_f32_16x16x32_bf16 v[120:123], v[16:19], v[144:147], v[120:123]
    v_cvt_pk_bf16_f32 v160, v104, v105
    v_cvt_pk_bf16_f32 v161, v106, v107
    v_cvt_pk_bf16_f32 v162, v108, v109
    v_cvt_pk_bf16_f32 v163, v110, v111
    s_nop 1
    v_permlane16_swap_b32 v160, v162
    v_permlane16_swap_b32 v161, v163
    s_nop 0
    buffer_store_dwordx4 v[160:163], v5, s[8:11], s31 offen sc1
    s_add_u32 s31, s31, 65536
    ds_read_b64_tr_b16 v[136:137], v168 offset:30848
    ds_read_b64_tr_b16 v[138:139], v168 offset:31616
    s_waitcnt lgkmcnt(10)
    v_mfma_f32_16x16x32_bf16 v[124:127], v[16:19], v[148:151], v[124:127]
    ds_read_b64_tr_b16 v[140:141], v169 offset:30880
    ds_read_b64_tr_b16 v[142:143], v169 offset:31648
    s_waitcnt lgkmcnt(10)
    v_mfma_f32_16x16x32_bf16 v[120:123], v[20:23], v[152:155], v[120:123]
    ds_read_b64_tr_b16 v[144:145], v170 offset:128
    ds_read_b64_tr_b16 v[146:147], v170 offset:896
    s_waitcnt lgkmcnt(10)
    v_mfma_f32_16x16x32_bf16 v[124:127], v[20:23], v[156:159], v[124:127]
    ds_read_b64_tr_b16 v[148:149], v171 offset:160
    ds_read_b64_tr_b16 v[150:151], v171 offset:928
    s_waitcnt lgkmcnt(10)
    v_mfma_f32_16x16x32_bf16 v[120:123], v[24:27], v[128:131], v[120:123]
    ds_read_b64_tr_b16 v[152:153], v170 offset:6272
    ds_read_b64_tr_b16 v[154:155], v170 offset:7040
    s_waitcnt lgkmcnt(10)
    v_mfma_f32_16x16x32_bf16 v[124:127], v[24:27], v[132:135], v[124:127]
    ds_read_b64_tr_b16 v[156:157], v171 offset:6304
    ds_read_b64_tr_b16 v[158:159], v171 offset:7072
    s_waitcnt lgkmcnt(10)
    v_mfma_f32_16x16x32_bf16 v[120:123], v[28:31], v[136:139], v[120:123]
    ds_read_b64_tr_b16 v[128:129], v170 offset:12416
    ds_read_b64_tr_b16 v[130:131], v170 offset:13184
    s_waitcnt lgkmcnt(10)
    v_mfma_f32_16x16x32_bf16 v[124:127], v[28:31], v[140:143], v[124:127]
    ds_read_b64_tr_b16 v[132:133], v171 offset:12448
    ds_read_b64_tr_b16 v[134:135], v171 offset:13216
    s_waitcnt lgkmcnt(10)
    v_mfma_f32_16x16x32_bf16 v[120:123], v[32:35], v[144:147], v[120:123]
    v_cvt_pk_bf16_f32 v164, v112, v113
    v_cvt_pk_bf16_f32 v165, v114, v115
    v_cvt_pk_bf16_f32 v166, v116, v117
    v_cvt_pk_bf16_f32 v167, v118, v119
    s_nop 1
    v_permlane16_swap_b32 v164, v166
    v_permlane16_swap_b32 v165, v167
    s_nop 0
    buffer_store_dwordx4 v[164:167], v5, s[8:11], s31 offen sc1
    s_add_u32 s31, s31, 65536
    ds_read_b64_tr_b16 v[136:137], v170 offset:18560
    ds_read_b64_tr_b16 v[138:139], v170 offset:19328
    s_waitcnt lgkmcnt(10)
    v_mfma_f32_16x16x32_bf16 v[124:127], v[32:35], v[148:151], v[124:127]
    ds_read_b64_tr_b16 v[140:141], v171 offset:18592
    ds_read_b64_tr_b16 v[142:143], v171 offset:19360
    s_waitcnt lgkmcnt(10)
    v_mfma_f32_16x16x32_bf16 v[120:123], v[36:39], v[152:155], v[120:123]
    ds_read_b64_tr_b16 v[144:145], v170 offset:24704
    ds_read_b64_tr_b16 v[146:147], v170 offset:25472
    s_waitcnt lgkmcnt(10)
    v_mfma_f32_16x16x32_bf16 v[124:127], v[36:39], v[156:159], v[124:127]
    ds_read_b64_tr_b16 v[148:149], v171 offset:24736
    ds_read_b64_tr_b16 v[150:151], v171 offset:25504
    s_waitcnt lgkmcnt(10)
    v_mfma_f32_16x16x32_bf16 v[120:123], v[40:43], v[128:131], v[120:123]
    ds_read_b64_tr_b16 v[152:153], v170 offset:30848
    ds_read_b64_tr_b16 v[154:155], v170 offset:31616
    s_waitcnt lgkmcnt(10)
    v_mfma_f32_16x16x32_bf16 v[124:127], v[40:43], v[132:135], v[124:127]
    ds_read_b64_tr_b16 v[156:157], v171 offset:30880
    ds_read_b64_tr_b16 v[158:159], v171 offset:31648
    s_waitcnt lgkmcnt(10)
    v_mfma_f32_16x16x32_bf16 v[120:123], v[44:47], v[136:139], v[120:123]
    s_waitcnt lgkmcnt(8)
    v_mfma_f32_16x16x32_bf16 v[124:127], v[44:47], v[140:143], v[124:127]
    s_waitcnt lgkmcnt(6)
    v_mfma_f32_16x16x32_bf16 v[120:123], v[48:51], v[144:147], v[120:123]
    s_waitcnt lgkmcnt(4)
    v_mfma_f32_16x16x32_bf16 v[124:127], v[48:51], v[148:151], v[124:127]
    s_waitcnt lgkmcnt(2)
    v_mfma_f32_16x16x32_bf16 v[120:123], v[52:55], v[152:155], v[120:123]
    s_waitcnt lgkmcnt(0)
    v_mfma_f32_16x16x32_bf16 v[124:127], v[52:55], v[156:159], v[124:127]
    s_nop 7
    v_cvt_pk_bf16_f32 v160, v120, v121
    v_cvt_pk_bf16_f32 v161, v122, v123
    v_cvt_pk_bf16_f32 v162, v124, v125
    v_cvt_pk_bf16_f32 v163, v126, v127
    s_nop 1
    v_permlane16_swap_b32 v160, v162
    v_permlane16_swap_b32 v161, v163
    s_nop 0
    buffer_store_dwordx4 v[160:163], v5, s[8:11], s31 offen sc1
    s_add_u32 s31, s31, 65536
    v_lshrrev_b32 v1, 6, v0
L_standalone__dit_block__diffusion_kernel_p1e:
    s_waitcnt vmcnt(0)
    s_barrier
    s_cmp_lg_u32 s3, 0
    s_cbranch_scc1 L_standalone__dit_block__diffusion_kernel_sg1
    v_mov_b32 v5, 0
    v_mov_b32 v6, 1
    s_lshl_b32 s35, s35, 5
    s_add_u32 s35, s35, 0x40000
    s_mov_b64 exec, 1
    buffer_store_dword v6, v5, s[8:11], s35 offen sc1
    s_mov_b64 exec, -1
L_standalone__dit_block__diffusion_kernel_sg1:
L_standalone__dit_block__diffusion_kernel_p1x:
    s_cmp_ge_u32 s3, 6
    s_cbranch_scc1 L_standalone__dit_block__diffusion_kernel_p3s
    v_mul_u32_u24 v6, 768, v2
    v_lshl_add_u32 v6, v3, 3, v6
    s_mul_i32 s29, s48, 24576
    s_lshl_b32 s6, s50, 5
    s_add_u32 s29, s29, s6
    s_add_u32 s30, s29, 12288
    buffer_load_dwordx2 v[248:249], v6, s[12:15], s29 offen
    buffer_load_dwordx2 v[250:251], v6, s[12:15], s30 offen
    v_lshrrev_b32 v168, 2, v2
    v_lshl_add_u32 v168, v3, 3, v168
    v_mul_u32_u24 v168, 192, v168
    v_and_b32 v169, 3, v2
    v_lshl_add_u32 v168, v169, 3, v168
    v_add_u32 v168, 77824, v168
    v_and_b32 v170, 1, v3
    v_lshlrev_b32 v170, 5, v170
    v_sub_u32 v169, v168, v170
    v_add_u32 v168, v168, v170
    v_add_u32 v170, 36864, v168
    v_add_u32 v171, 36864, v169
    s_bitcmp1_b32 s3, 0
    s_cselect_b64 vcc, -1, 0
    s_lshl_b32 s6, s3, 5
    v_cndmask_b32 v168, v168, v169, vcc
    v_add_u32 v168, s6, v168
    v_add_u32 v169, 36864, v168
    ds_read_b64_tr_b16 v[200:201], v168 offset:0
    ds_read_b64_tr_b16 v[202:203], v168 offset:768
    ds_read_b64_tr_b16 v[204:205], v168 offset:6144
    ds_read_b64_tr_b16 v[206:207], v168 offset:6912
    ds_read_b64_tr_b16 v[208:209], v168 offset:12288
    ds_read_b64_tr_b16 v[210:211], v168 offset:13056
    ds_read_b64_tr_b16 v[212:213], v168 offset:18432
    ds_read_b64_tr_b16 v[214:215], v168 offset:19200
    ds_read_b64_tr_b16 v[216:217], v168 offset:24576
    ds_read_b64_tr_b16 v[218:219], v168 offset:25344
    ds_read_b64_tr_b16 v[220:221], v168 offset:30720
    ds_read_b64_tr_b16 v[222:223], v168 offset:31488
    ds_read_b64_tr_b16 v[224:225], v169 offset:0
    ds_read_b64_tr_b16 v[226:227], v169 offset:768
    ds_read_b64_tr_b16 v[228:229], v169 offset:6144
    ds_read_b64_tr_b16 v[230:231], v169 offset:6912
    ds_read_b64_tr_b16 v[232:233], v169 offset:12288
    ds_read_b64_tr_b16 v[234:235], v169 offset:13056
    ds_read_b64_tr_b16 v[236:237], v169 offset:18432
    ds_read_b64_tr_b16 v[238:239], v169 offset:19200
    ds_read_b64_tr_b16 v[240:241], v169 offset:24576
    ds_read_b64_tr_b16 v[242:243], v169 offset:25344
    ds_read_b64_tr_b16 v[244:245], v169 offset:30720
    ds_read_b64_tr_b16 v[246:247], v169 offset:31488
    s_waitcnt lgkmcnt(0)
L_standalone__dit_block__diffusion_kernel_p3s:
    s_lshr_b32 s20, s4, 2
    s_bfe_u32 s21, s5, 0x10002
    s_lshr_b32 s22, s5, 3
    s_and_b32 s23, s4, 3
    s_lshl_b32 s23, s23, 2
    s_and_b32 s6, s5, 3
    s_add_u32 s23, s23, s6
    s_lshl_b32 s24, s20, 6
    s_lshl_b32 s6, s23, 2
    s_add_u32 s24, s24, s6
    s_lshr_b32 s6, s3, 1
    s_add_u32 s25, s24, s6
    s_mul_i32 s25, s25, 12
    s_mul_i32 s26, s21, 6
    s_add_u32 s25, s25, s26
    s_and_b32 s6, s3, 1
    s_mul_i32 s6, s6, 3
    s_add_u32 s25, s25, s6
    s_lshl_b32 s25, s25, 10
    s_add_u32 s25, s25, 0x600000
    s_lshl_b32 s27, s20, 6
    s_lshl_b32 s6, s22, 4
    s_add_u32 s27, s27, s6
    s_lshl_b32 s6, s3, 1
    s_add_u32 s27, s27, s6
    s_mul_i32 s27, s27, 12
    s_add_u32 s27, s27, s26
    s_lshl_b32 s27, s27, 10
    s_add_u32 s27, s27, 0x780000
    s_add_u32 s36, s27, 12288
    s_mul_i32 s28, s20, 24
    s_mul_i32 s6, s21, 12
    s_add_u32 s28, s28, s6
    s_lshl_b32 s28, s28, 5
    s_lshl_b32 s6, s22, 3
    s_add_u32 s28, s28, s6
    s_add_u32 s28, s28, s3
    s_lshl_b32 s28, s28, 10
    s_add_u32 s28, s28, 0x900000
    s_lshl_b32 s29, s3, 10
    s_add_u32 s29, s29, 57344
    s_cmp_lg_u32 s3, 7
    s_cbranch_scc1 L_standalone__dit_block__diffusion_kernel_pd2
    v_bfe_u32 v6, v0, 2, 2
    v_min_u32 v6, 2, v6
    v_bfe_u32 v7, v0, 1, 1
    s_lshl_b32 s6, s22, 1
    v_add_u32 v7, s6, v7
    s_lshr_b32 s6, s23, 1
    v_mov_b32 v5, s6
    v_cmp_eq_u32 vcc, 0, v6
    s_lshl_b32 s6, s20, 9
    s_lshl_b32 s7, s21, 3
    v_cndmask_b32 v7, v7, v5, vcc
    s_add_u32 s6, s6, s7
    v_lshlrev_b32 v7, 6, v7
    v_lshl_add_u32 v7, v6, 4, v7
    v_and_b32 v6, 1, v0
    v_lshl_add_u32 v7, v6, 2, v7
    v_add_u32 v5, s6, v7
    v_lshlrev_b32 v5, 5, v5
    s_mov_b32 s6, 0x40000
    s_mov_b32 s7, 0
L_standalone__dit_block__diffusion_kernel_pl2:
    buffer_load_dword v6, v5, s[8:11], s6 offen sc1
    s_waitcnt vmcnt(0)
    v_cmp_eq_u32 vcc, 0, v6
    s_add_u32 s7, s7, 1
    s_cmp_ge_u32 s7, 0x10000
    s_cbranch_scc1 L_standalone__dit_block__diffusion_kernel_pd2
    s_nop 2
    s_cbranch_vccz L_standalone__dit_block__diffusion_kernel_pd2
    s_sleep 3
    s_branch L_standalone__dit_block__diffusion_kernel_pl2
L_standalone__dit_block__diffusion_kernel_pd2:
    s_barrier
    s_mul_i32 s6, s3, 3072
    s_mov_b32 m0, s6
    s_nop 0
    buffer_load_dwordx4 v4, s[8:11], s25 offen sc1 lds
    buffer_load_dwordx4 v4, s[8:11], s25 offen offset:1024 sc1 lds
    buffer_load_dwordx4 v4, s[8:11], s25 offen offset:2048 sc1 lds
    buffer_load_dwordx4 v[8:11], v4, s[8:11], s27 offen sc1
    buffer_load_dwordx4 v[32:35], v4, s[8:11], s36 offen sc1
    buffer_load_dwordx4 v[12:15], v4, s[8:11], s27 offen offset:1024 sc1
    buffer_load_dwordx4 v[36:39], v4, s[8:11], s36 offen offset:1024 sc1
    buffer_load_dwordx4 v[16:19], v4, s[8:11], s27 offen offset:2048 sc1
    buffer_load_dwordx4 v[40:43], v4, s[8:11], s36 offen offset:2048 sc1
    buffer_load_dwordx4 v[20:23], v4, s[8:11], s27 offen offset:3072 sc1
    buffer_load_dwordx4 v[44:47], v4, s[8:11], s36 offen offset:3072 sc1
    s_add_u32 s27, s27, 4096
    s_add_u32 s36, s36, 4096
    buffer_load_dwordx4 v[24:27], v4, s[8:11], s27 offen sc1
    buffer_load_dwordx4 v[48:51], v4, s[8:11], s36 offen sc1
    buffer_load_dwordx4 v[28:31], v4, s[8:11], s27 offen offset:1024 sc1
    buffer_load_dwordx4 v[52:55], v4, s[8:11], s36 offen offset:1024 sc1
    s_waitcnt vmcnt(12)
    s_barrier
    ds_read_b128 v[88:91], v4 offset:0
    ds_read_b128 v[92:95], v4 offset:6144
    ds_read_b128 v[96:99], v4 offset:12288
    ds_read_b128 v[100:103], v4 offset:18432
    ds_read_b128 v[104:107], v4 offset:1024
    ds_read_b128 v[108:111], v4 offset:7168
    ds_read_b128 v[112:115], v4 offset:13312
    ds_read_b128 v[116:119], v4 offset:19456
    s_waitcnt lgkmcnt(7)
    s_waitcnt vmcnt(10)
    s_mov_b32 m0, s29
    s_add_u32 s29, s29, 8192
    buffer_load_dwordx4 v4, s[8:11], s28 offen sc1 lds
    s_add_u32 s28, s28, 32768
    v_mfma_f32_16x16x32_bf16 v[56:59], v[8:11], v[88:91], 0
    v_mfma_f32_16x16x32_bf16 v[60:63], v[32:35], v[88:91], 0
    ds_read_b128 v[88:91], v4 offset:2048
    s_waitcnt lgkmcnt(7)
    v_mfma_f32_16x16x32_bf16 v[64:67], v[8:11], v[92:95], 0
    v_mfma_f32_16x16x32_bf16 v[68:71], v[32:35], v[92:95], 0
    ds_read_b128 v[92:95], v4 offset:8192
    s_waitcnt lgkmcnt(7)
    s_mov_b32 m0, s29
    s_add_u32 s29, s29, 8192
    buffer_load_dwordx4 v4, s[8:11], s28 offen sc1 lds
    s_add_u32 s28, s28, 32768
    v_mfma_f32_16x16x32_bf16 v[72:75], v[8:11], v[96:99], 0
    v_mfma_f32_16x16x32_bf16 v[76:79], v[32:35], v[96:99], 0
    ds_read_b128 v[96:99], v4 offset:14336
    s_waitcnt lgkmcnt(7)
    v_mfma_f32_16x16x32_bf16 v[80:83], v[8:11], v[100:103], 0
    v_mfma_f32_16x16x32_bf16 v[84:87], v[32:35], v[100:103], 0
    ds_read_b128 v[100:103], v4 offset:20480
    s_waitcnt lgkmcnt(7)
    s_waitcnt vmcnt(10)
    s_mov_b32 m0, s29
    s_add_u32 s29, s29, 8192
    buffer_load_dwordx4 v4, s[8:11], s28 offen sc1 lds
    s_add_u32 s28, s28, 32768
    v_mfma_f32_16x16x32_bf16 v[56:59], v[12:15], v[104:107], v[56:59]
    v_mfma_f32_16x16x32_bf16 v[60:63], v[36:39], v[104:107], v[60:63]
    ds_read_b128 v[104:107], v4 offset:3072
    s_waitcnt lgkmcnt(7)
    v_mfma_f32_16x16x32_bf16 v[64:67], v[12:15], v[108:111], v[64:67]
    v_mfma_f32_16x16x32_bf16 v[68:71], v[36:39], v[108:111], v[68:71]
    ds_read_b128 v[108:111], v4 offset:9216
    s_waitcnt lgkmcnt(7)
    s_mov_b32 m0, s29
    s_add_u32 s29, s29, 8192
    buffer_load_dwordx4 v4, s[8:11], s28 offen sc1 lds
    s_add_u32 s28, s28, 32768
    v_mfma_f32_16x16x32_bf16 v[72:75], v[12:15], v[112:115], v[72:75]
    v_mfma_f32_16x16x32_bf16 v[76:79], v[36:39], v[112:115], v[76:79]
    ds_read_b128 v[112:115], v4 offset:15360
    s_waitcnt lgkmcnt(7)
    v_mfma_f32_16x16x32_bf16 v[80:83], v[12:15], v[116:119], v[80:83]
    v_mfma_f32_16x16x32_bf16 v[84:87], v[36:39], v[116:119], v[84:87]
    ds_read_b128 v[116:119], v4 offset:21504
    s_waitcnt lgkmcnt(7)
    s_waitcnt vmcnt(10)
    s_mov_b32 m0, s29
    s_add_u32 s29, s29, 8192
    buffer_load_dwordx4 v4, s[8:11], s28 offen sc1 lds
    s_add_u32 s28, s28, 32768
    v_mfma_f32_16x16x32_bf16 v[56:59], v[16:19], v[88:91], v[56:59]
    v_mfma_f32_16x16x32_bf16 v[60:63], v[40:43], v[88:91], v[60:63]
    ds_read_b128 v[88:91], v4 offset:4096
    s_waitcnt lgkmcnt(7)
    v_mfma_f32_16x16x32_bf16 v[64:67], v[16:19], v[92:95], v[64:67]
    v_mfma_f32_16x16x32_bf16 v[68:71], v[40:43], v[92:95], v[68:71]
    ds_read_b128 v[92:95], v4 offset:10240
    s_waitcnt lgkmcnt(7)
    s_mov_b32 m0, s29
    s_add_u32 s29, s29, 8192
    buffer_load_dwordx4 v4, s[8:11], s28 offen sc1 lds
    s_add_u32 s28, s28, 32768
    v_mfma_f32_16x16x32_bf16 v[72:75], v[16:19], v[96:99], v[72:75]
    v_mfma_f32_16x16x32_bf16 v[76:79], v[40:43], v[96:99], v[76:79]
    ds_read_b128 v[96:99], v4 offset:16384
    s_waitcnt lgkmcnt(7)
    v_mfma_f32_16x16x32_bf16 v[80:83], v[16:19], v[100:103], v[80:83]
    v_mfma_f32_16x16x32_bf16 v[84:87], v[40:43], v[100:103], v[84:87]
    ds_read_b128 v[100:103], v4 offset:22528
    s_waitcnt lgkmcnt(7)
    s_waitcnt vmcnt(10)
    s_mov_b32 m0, s29
    s_add_u32 s29, s29, 8192
    buffer_load_dwordx4 v4, s[8:11], s28 offen sc1 lds
    s_add_u32 s28, s28, 32768
    v_mfma_f32_16x16x32_bf16 v[56:59], v[20:23], v[104:107], v[56:59]
    v_mfma_f32_16x16x32_bf16 v[60:63], v[44:47], v[104:107], v[60:63]
    ds_read_b128 v[104:107], v4 offset:5120
    s_waitcnt lgkmcnt(7)
    v_mfma_f32_16x16x32_bf16 v[64:67], v[20:23], v[108:111], v[64:67]
    v_mfma_f32_16x16x32_bf16 v[68:71], v[44:47], v[108:111], v[68:71]
    ds_read_b128 v[108:111], v4 offset:11264
    s_waitcnt lgkmcnt(7)
    s_mov_b32 m0, s29
    s_add_u32 s29, s29, 8192
    buffer_load_dwordx4 v4, s[8:11], s28 offen sc1 lds
    s_add_u32 s28, s28, 32768
    v_mfma_f32_16x16x32_bf16 v[72:75], v[20:23], v[112:115], v[72:75]
    v_mfma_f32_16x16x32_bf16 v[76:79], v[44:47], v[112:115], v[76:79]
    ds_read_b128 v[112:115], v4 offset:17408
    s_waitcnt lgkmcnt(7)
    v_mfma_f32_16x16x32_bf16 v[80:83], v[20:23], v[116:119], v[80:83]
    v_mfma_f32_16x16x32_bf16 v[84:87], v[44:47], v[116:119], v[84:87]
    ds_read_b128 v[116:119], v4 offset:23552
    s_waitcnt lgkmcnt(7)
    s_waitcnt vmcnt(10)
    s_mov_b32 m0, s29
    s_add_u32 s29, s29, 8192
    buffer_load_dwordx4 v4, s[8:11], s28 offen sc1 lds
    s_add_u32 s28, s28, 32768
    v_mfma_f32_16x16x32_bf16 v[56:59], v[24:27], v[88:91], v[56:59]
    v_mfma_f32_16x16x32_bf16 v[60:63], v[48:51], v[88:91], v[60:63]
    s_waitcnt lgkmcnt(6)
    v_mfma_f32_16x16x32_bf16 v[64:67], v[24:27], v[92:95], v[64:67]
    v_mfma_f32_16x16x32_bf16 v[68:71], v[48:51], v[92:95], v[68:71]
    s_waitcnt lgkmcnt(5)
    s_mov_b32 m0, s29
    s_add_u32 s29, s29, 8192
    buffer_load_dwordx4 v4, s[8:11], s28 offen sc1 lds
    s_add_u32 s28, s28, 32768
    v_mfma_f32_16x16x32_bf16 v[72:75], v[24:27], v[96:99], v[72:75]
    v_mfma_f32_16x16x32_bf16 v[76:79], v[48:51], v[96:99], v[76:79]
    s_waitcnt lgkmcnt(4)
    v_mfma_f32_16x16x32_bf16 v[80:83], v[24:27], v[100:103], v[80:83]
    v_mfma_f32_16x16x32_bf16 v[84:87], v[48:51], v[100:103], v[84:87]
    s_waitcnt lgkmcnt(3)
    s_waitcnt vmcnt(10)
    s_mov_b32 m0, s29
    s_add_u32 s29, s29, 8192
    buffer_load_dwordx4 v4, s[8:11], s28 offen sc1 lds
    s_add_u32 s28, s28, 32768
    v_mfma_f32_16x16x32_bf16 v[56:59], v[28:31], v[104:107], v[56:59]
    v_mfma_f32_16x16x32_bf16 v[60:63], v[52:55], v[104:107], v[60:63]
    s_waitcnt lgkmcnt(2)
    v_mfma_f32_16x16x32_bf16 v[64:67], v[28:31], v[108:111], v[64:67]
    v_mfma_f32_16x16x32_bf16 v[68:71], v[52:55], v[108:111], v[68:71]
    s_waitcnt lgkmcnt(1)
    s_mov_b32 m0, s29
    s_add_u32 s29, s29, 8192
    buffer_load_dwordx4 v4, s[8:11], s28 offen sc1 lds
    s_add_u32 s28, s28, 32768
    v_mfma_f32_16x16x32_bf16 v[72:75], v[28:31], v[112:115], v[72:75]
    v_mfma_f32_16x16x32_bf16 v[76:79], v[52:55], v[112:115], v[76:79]
    s_waitcnt lgkmcnt(0)
    v_mfma_f32_16x16x32_bf16 v[80:83], v[28:31], v[116:119], v[80:83]
    v_mfma_f32_16x16x32_bf16 v[84:87], v[52:55], v[116:119], v[84:87]
    v_lshrrev_b32 v5, 4, v4
    v_min_u32 v5, 59, v5
    v_lshlrev_b32 v5, 2, v5
    v_add_u32 v5, 1024, v5
    v_lshlrev_b32 v5, 5, v5
    s_mov_b32 s6, 0x40000
    buffer_load_dword v199, v5, s[8:11], s6 offen sc1
    v_and_b32 v5, 63, v0
    v_lshlrev_b32 v5, 5, v5
    v_lshl_add_u32 v5, v1, 2, v5
    v_add_u32 v5, 155648, v5
    v_lshlrev_b32 v6, 5, v2
    v_add_u32 v6, 155648, v6
    s_lshl_b32 s6, s3, 10
    s_add_u32 s6, s6, 24576
    v_add_u32 v7, s6, v4
    v_max3_f32 v8, v56, v57, v58
    v_max3_f32 v8, v8, v59, v60
    v_max3_f32 v8, v8, v61, v62
    v_max_f32 v8, v8, v63
    v_max3_f32 v9, v64, v65, v66
    v_max3_f32 v9, v9, v67, v68
    v_max3_f32 v9, v9, v69, v70
    v_max_f32 v9, v9, v71
    v_max3_f32 v10, v72, v73, v74
    v_max3_f32 v10, v10, v75, v76
    v_max3_f32 v10, v10, v77, v78
    v_max_f32 v10, v10, v79
    v_max3_f32 v11, v80, v81, v82
    v_max3_f32 v11, v11, v83, v84
    v_max3_f32 v11, v11, v85, v86
    v_max_f32 v11, v11, v87
    s_nop 1
    v_permlane32_swap_b32 v8, v10
    v_permlane32_swap_b32 v9, v11
    s_nop 1
    v_max_f32 v8, v8, v10
    v_max_f32 v9, v9, v11
    s_nop 1
    v_permlane16_swap_b32 v8, v9
    s_nop 1
    v_max_f32 v8, v8, v9
    ds_write_b32 v5, v8 offset:0
    s_waitcnt lgkmcnt(0)
    s_barrier
    ds_read_b128 v[16:19], v6 offset:0
    ds_read_b128 v[20:23], v6 offset:16
    ds_read_b128 v[24:27], v6 offset:512
    ds_read_b128 v[28:31], v6 offset:528
    ds_read_b128 v[32:35], v6 offset:1024
    ds_read_b128 v[36:39], v6 offset:1040
    ds_read_b128 v[40:43], v6 offset:1536
    ds_read_b128 v[44:47], v6 offset:1552
    s_waitcnt lgkmcnt(6)
    v_max3_f32 v120, v16, v17, v18
    v_max3_f32 v120, v120, v19, v20
    v_max3_f32 v120, v120, v21, v22
    v_max_f32 v120, v120, v23
    s_waitcnt lgkmcnt(4)
    v_max3_f32 v121, v24, v25, v26
    v_max3_f32 v121, v121, v27, v28
    v_max3_f32 v121, v121, v29, v30
    v_max_f32 v121, v121, v31
    s_waitcnt lgkmcnt(2)
    v_max3_f32 v122, v32, v33, v34
    v_max3_f32 v122, v122, v35, v36
    v_max3_f32 v122, v122, v37, v38
    v_max_f32 v122, v122, v39
    s_waitcnt lgkmcnt(0)
    v_max3_f32 v123, v40, v41, v42
    v_max3_f32 v123, v123, v43, v44
    v_max3_f32 v123, v123, v45, v46
    v_max_f32 v123, v123, v47
    s_mov_b32 s40, 0x3f803f80
    v_pk_add_f32 v[56:57], v[56:57], v[120:121] op_sel:[0,0] op_sel_hi:[1,0] neg_lo:[0,1] neg_hi:[0,1]
    v_pk_add_f32 v[58:59], v[58:59], v[120:121] op_sel:[0,0] op_sel_hi:[1,0] neg_lo:[0,1] neg_hi:[0,1]
    v_pk_add_f32 v[60:61], v[60:61], v[120:121] op_sel:[0,0] op_sel_hi:[1,0] neg_lo:[0,1] neg_hi:[0,1]
    v_pk_add_f32 v[62:63], v[62:63], v[120:121] op_sel:[0,0] op_sel_hi:[1,0] neg_lo:[0,1] neg_hi:[0,1]
    v_exp_f32 v56, v56
    v_exp_f32 v57, v57
    v_exp_f32 v58, v58
    v_exp_f32 v59, v59
    v_exp_f32 v60, v60
    v_exp_f32 v61, v61
    v_exp_f32 v62, v62
    v_exp_f32 v63, v63
    s_nop 0
    v_cvt_pk_bf16_f32 v88, v56, v57
    v_cvt_pk_bf16_f32 v89, v58, v59
    v_cvt_pk_bf16_f32 v90, v60, v61
    v_cvt_pk_bf16_f32 v91, v62, v63
    ds_write_b128 v7, v[88:91] offset:0
    v_pk_add_f32 v[56:57], v[56:57], v[58:59] op_sel:[0,0] op_sel_hi:[1,1]
    v_pk_add_f32 v[60:61], v[60:61], v[62:63] op_sel:[0,0] op_sel_hi:[1,1]
    v_pk_add_f32 v[56:57], v[56:57], v[60:61] op_sel:[0,0] op_sel_hi:[1,1]
    v_add_f32 v8, v56, v57
    v_pk_add_f32 v[64:65], v[64:65], v[120:121] op_sel:[0,1] op_sel_hi:[1,1] neg_lo:[0,1] neg_hi:[0,1]
    v_pk_add_f32 v[66:67], v[66:67], v[120:121] op_sel:[0,1] op_sel_hi:[1,1] neg_lo:[0,1] neg_hi:[0,1]
    v_pk_add_f32 v[68:69], v[68:69], v[120:121] op_sel:[0,1] op_sel_hi:[1,1] neg_lo:[0,1] neg_hi:[0,1]
    v_pk_add_f32 v[70:71], v[70:71], v[120:121] op_sel:[0,1] op_sel_hi:[1,1] neg_lo:[0,1] neg_hi:[0,1]
    v_exp_f32 v64, v64
    v_exp_f32 v65, v65
    v_exp_f32 v66, v66
    v_exp_f32 v67, v67
    v_exp_f32 v68, v68
    v_exp_f32 v69, v69
    v_exp_f32 v70, v70
    v_exp_f32 v71, v71
    s_nop 0
    v_cvt_pk_bf16_f32 v92, v64, v65
    v_cvt_pk_bf16_f32 v93, v66, v67
    v_cvt_pk_bf16_f32 v94, v68, v69
    v_cvt_pk_bf16_f32 v95, v70, v71
    ds_write_b128 v7, v[92:95] offset:8192
    v_pk_add_f32 v[64:65], v[64:65], v[66:67] op_sel:[0,0] op_sel_hi:[1,1]
    v_pk_add_f32 v[68:69], v[68:69], v[70:71] op_sel:[0,0] op_sel_hi:[1,1]
    v_pk_add_f32 v[64:65], v[64:65], v[68:69] op_sel:[0,0] op_sel_hi:[1,1]
    v_add_f32 v9, v64, v65
    v_pk_add_f32 v[72:73], v[72:73], v[122:123] op_sel:[0,0] op_sel_hi:[1,0] neg_lo:[0,1] neg_hi:[0,1]
    v_pk_add_f32 v[74:75], v[74:75], v[122:123] op_sel:[0,0] op_sel_hi:[1,0] neg_lo:[0,1] neg_hi:[0,1]
    v_pk_add_f32 v[76:77], v[76:77], v[122:123] op_sel:[0,0] op_sel_hi:[1,0] neg_lo:[0,1] neg_hi:[0,1]
    v_pk_add_f32 v[78:79], v[78:79], v[122:123] op_sel:[0,0] op_sel_hi:[1,0] neg_lo:[0,1] neg_hi:[0,1]
    v_exp_f32 v72, v72
    v_exp_f32 v73, v73
    v_exp_f32 v74, v74
    v_exp_f32 v75, v75
    v_exp_f32 v76, v76
    v_exp_f32 v77, v77
    v_exp_f32 v78, v78
    v_exp_f32 v79, v79
    s_nop 0
    v_cvt_pk_bf16_f32 v96, v72, v73
    v_cvt_pk_bf16_f32 v97, v74, v75
    v_cvt_pk_bf16_f32 v98, v76, v77
    v_cvt_pk_bf16_f32 v99, v78, v79
    ds_write_b128 v7, v[96:99] offset:16384
    v_pk_add_f32 v[72:73], v[72:73], v[74:75] op_sel:[0,0] op_sel_hi:[1,1]
    v_pk_add_f32 v[76:77], v[76:77], v[78:79] op_sel:[0,0] op_sel_hi:[1,1]
    v_pk_add_f32 v[72:73], v[72:73], v[76:77] op_sel:[0,0] op_sel_hi:[1,1]
    v_add_f32 v10, v72, v73
    v_pk_add_f32 v[80:81], v[80:81], v[122:123] op_sel:[0,1] op_sel_hi:[1,1] neg_lo:[0,1] neg_hi:[0,1]
    v_pk_add_f32 v[82:83], v[82:83], v[122:123] op_sel:[0,1] op_sel_hi:[1,1] neg_lo:[0,1] neg_hi:[0,1]
    v_pk_add_f32 v[84:85], v[84:85], v[122:123] op_sel:[0,1] op_sel_hi:[1,1] neg_lo:[0,1] neg_hi:[0,1]
    v_pk_add_f32 v[86:87], v[86:87], v[122:123] op_sel:[0,1] op_sel_hi:[1,1] neg_lo:[0,1] neg_hi:[0,1]
    v_exp_f32 v80, v80
    v_exp_f32 v81, v81
    v_exp_f32 v82, v82
    v_exp_f32 v83, v83
    v_exp_f32 v84, v84
    v_exp_f32 v85, v85
    v_exp_f32 v86, v86
    v_exp_f32 v87, v87
    s_nop 0
    v_cvt_pk_bf16_f32 v100, v80, v81
    v_cvt_pk_bf16_f32 v101, v82, v83
    v_cvt_pk_bf16_f32 v102, v84, v85
    v_cvt_pk_bf16_f32 v103, v86, v87
    ds_write_b128 v7, v[100:103] offset:24576
    v_pk_add_f32 v[80:81], v[80:81], v[82:83] op_sel:[0,0] op_sel_hi:[1,1]
    v_pk_add_f32 v[84:85], v[84:85], v[86:87] op_sel:[0,0] op_sel_hi:[1,1]
    v_pk_add_f32 v[80:81], v[80:81], v[84:85] op_sel:[0,0] op_sel_hi:[1,1]
    v_add_f32 v11, v80, v81
    s_nop 1
    s_nop 1
    v_permlane32_swap_b32 v8, v10
    v_permlane32_swap_b32 v9, v11
    s_nop 1
    v_add_f32 v8, v8, v10
    v_add_f32 v9, v9, v11
    s_nop 1
    v_permlane16_swap_b32 v8, v9
    s_nop 1
    v_add_f32 v8, v8, v9
    ds_write_b32 v5, v8 offset:2048
    s_waitcnt vmcnt(0) lgkmcnt(0)
    v_cmp_eq_u32 vcc, 0, v199
    v_mov_b32 v198, v6
    s_nop 3
    s_cbranch_vccz L_standalone__dit_block__diffusion_kernel_pds
    s_cmp_lg_u32 s3, 7
    s_cbranch_scc1 L_standalone__dit_block__diffusion_kernel_pds
    v_lshrrev_b32 v5, 4, v4
    v_min_u32 v5, 59, v5
    v_lshlrev_b32 v5, 2, v5
    v_add_u32 v5, 1024, v5
    v_lshlrev_b32 v5, 5, v5
    s_mov_b32 s6, 0x40000
    s_mov_b32 s7, 0
L_standalone__dit_block__diffusion_kernel_pls:
    buffer_load_dword v6, v5, s[8:11], s6 offen sc1
    s_waitcnt vmcnt(0)
    v_cmp_eq_u32 vcc, 0, v6
    s_add_u32 s7, s7, 1
    s_cmp_ge_u32 s7, 0x10000
    s_cbranch_scc1 L_standalone__dit_block__diffusion_kernel_pds
    s_nop 2
    s_cbranch_vccz L_standalone__dit_block__diffusion_kernel_pds
    s_sleep 3
    s_branch L_standalone__dit_block__diffusion_kernel_pls
L_standalone__dit_block__diffusion_kernel_pds:
    v_mov_b32 v6, v198
    s_and_b32 s30, s3, 3
    s_lshr_b32 s31, s3, 2
    s_mul_i32 s6, s30, 24576
    s_add_u32 s6, s6, 57344
    v_add_u32 v5, s6, v4
    s_lshl_b32 s6, s31, 14
    s_add_u32 s6, s6, 24576
    v_add_u32 v7, s6, v4
    s_lshl_b32 s6, s31, 10
    v_add_u32 v6, s6, v6
    s_cmp_eq_u32 s31, 0
    s_cselect_b64 vcc, -1, 0
    v_cndmask_b32 v120, v122, v120, vcc
    v_cndmask_b32 v121, v123, v121, vcc
    s_waitcnt vmcnt(0) lgkmcnt(0)
    s_barrier
    ds_read_b128 v[16:19], v6 offset:2048
    ds_read_b128 v[20:23], v6 offset:2064
    ds_read_b128 v[24:27], v6 offset:2560
    ds_read_b128 v[28:31], v6 offset:2576
    s_lshl_b32 s6, s31, 1
    s_add_u32 s24, s24, s6
    s_mul_i32 s32, s24, 12288
    s_mul_i32 s6, s22, 0x180000
    s_add_u32 s32, s32, s6
    s_add_u32 s32, s32, 0xb00000
    s_mul_i32 s33, s21, 12
    s_mul_i32 s6, s30, 3
    s_add_u32 s33, s33, s6
    s_lshl_b32 s33, s33, 9
    s_add_u32 s32, s32, s33
    v_and_b32 v197, 1, v3
    v_mul_u32_u24 v197, 12288, v197
    v_lshrrev_b32 v6, 1, v3
    v_lshl_add_u32 v197, v6, 8, v197
    v_lshl_add_u32 v197, v2, 4, v197
    ds_read_b128 v[128:131], v7 offset:0
    ds_read_b128 v[160:163], v7 offset:8192
    ds_read_b128 v[88:91], v5 offset:0
    ds_read_b128 v[132:135], v7 offset:1024
    ds_read_b128 v[164:167], v7 offset:9216
    ds_read_b128 v[92:95], v5 offset:1024
    ds_read_b128 v[136:139], v7 offset:2048
    ds_read_b128 v[168:171], v7 offset:10240
    ds_read_b128 v[96:99], v5 offset:2048
    ds_read_b128 v[140:143], v7 offset:3072
    ds_read_b128 v[172:175], v7 offset:11264
    s_waitcnt lgkmcnt(8)
    v_mfma_f32_16x16x32_bf16 v[56:59], v[88:91], v[128:131], 0
    v_mfma_f32_16x16x32_bf16 v[60:63], v[88:91], v[160:163], 0
    ds_read_b128 v[100:103], v5 offset:3072
    ds_read_b128 v[144:147], v7 offset:4096
    ds_read_b128 v[176:179], v7 offset:12288
    s_waitcnt lgkmcnt(8)
    v_mfma_f32_16x16x32_bf16 v[56:59], v[92:95], v[132:135], v[56:59]
    v_mfma_f32_16x16x32_bf16 v[60:63], v[92:95], v[164:167], v[60:63]
    v_add_f32 v16, v16, v17
    v_add_f32 v16, v16, v18
    v_add_f32 v16, v16, v19
    v_add_f32 v16, v16, v20
    v_add_f32 v16, v16, v21
    v_add_f32 v16, v16, v22
    v_add_f32 v16, v16, v23
    v_rcp_f32 v17, v16
    v_log_f32 v18, v16
    v_add_f32 v24, v24, v25
    v_add_f32 v24, v24, v26
    v_add_f32 v24, v24, v27
    v_add_f32 v24, v24, v28
    v_add_f32 v24, v24, v29
    v_add_f32 v24, v24, v30
    v_add_f32 v24, v24, v31
    v_rcp_f32 v25, v24
    v_log_f32 v26, v24
    ds_read_b128 v[104:107], v5 offset:4096
    ds_read_b128 v[148:151], v7 offset:5120
    ds_read_b128 v[180:183], v7 offset:13312
    s_waitcnt lgkmcnt(8)
    v_mfma_f32_16x16x32_bf16 v[56:59], v[96:99], v[136:139], v[56:59]
    v_mfma_f32_16x16x32_bf16 v[60:63], v[96:99], v[168:171], v[60:63]
    ds_read_b128 v[108:111], v5 offset:5120
    ds_read_b128 v[152:155], v7 offset:6144
    ds_read_b128 v[184:187], v7 offset:14336
    s_waitcnt lgkmcnt(8)
    v_mfma_f32_16x16x32_bf16 v[56:59], v[100:103], v[140:143], v[56:59]
    v_mfma_f32_16x16x32_bf16 v[60:63], v[100:103], v[172:175], v[60:63]
    ds_read_b128 v[112:115], v5 offset:6144
    ds_read_b128 v[156:159], v7 offset:7168
    ds_read_b128 v[188:191], v7 offset:15360
    s_waitcnt lgkmcnt(8)
    v_mfma_f32_16x16x32_bf16 v[56:59], v[104:107], v[144:147], v[56:59]
    v_mfma_f32_16x16x32_bf16 v[60:63], v[104:107], v[176:179], v[60:63]
    ds_read_b128 v[116:119], v5 offset:7168
    ds_read_b128 v[88:91], v5 offset:8192
    ds_read_b128 v[92:95], v5 offset:9216
    s_waitcnt lgkmcnt(8)
    v_mfma_f32_16x16x32_bf16 v[56:59], v[108:111], v[148:151], v[56:59]
    v_mfma_f32_16x16x32_bf16 v[60:63], v[108:111], v[180:183], v[60:63]
    ds_read_b128 v[96:99], v5 offset:10240
    ds_read_b128 v[100:103], v5 offset:11264
    ds_read_b128 v[104:107], v5 offset:12288
    s_waitcnt lgkmcnt(8)
    v_mfma_f32_16x16x32_bf16 v[56:59], v[112:115], v[152:155], v[56:59]
    v_mfma_f32_16x16x32_bf16 v[60:63], v[112:115], v[184:187], v[60:63]
    ds_read_b128 v[108:111], v5 offset:13312
    s_waitcnt lgkmcnt(6)
    v_mfma_f32_16x16x32_bf16 v[56:59], v[116:119], v[156:159], v[56:59]
    v_mfma_f32_16x16x32_bf16 v[60:63], v[116:119], v[188:191], v[60:63]
    ds_read_b128 v[112:115], v5 offset:14336
    s_waitcnt lgkmcnt(6)
    v_mfma_f32_16x16x32_bf16 v[64:67], v[88:91], v[128:131], 0
    v_mfma_f32_16x16x32_bf16 v[68:71], v[88:91], v[160:163], 0
    ds_read_b128 v[116:119], v5 offset:15360
    s_waitcnt lgkmcnt(6)
    v_mfma_f32_16x16x32_bf16 v[64:67], v[92:95], v[132:135], v[64:67]
    v_mfma_f32_16x16x32_bf16 v[68:71], v[92:95], v[164:167], v[68:71]
    ds_read_b128 v[88:91], v5 offset:16384
    s_waitcnt lgkmcnt(6)
    v_mfma_f32_16x16x32_bf16 v[64:67], v[96:99], v[136:139], v[64:67]
    v_mfma_f32_16x16x32_bf16 v[68:71], v[96:99], v[168:171], v[68:71]
    ds_read_b128 v[92:95], v5 offset:17408
    s_waitcnt lgkmcnt(6)
    v_mfma_f32_16x16x32_bf16 v[64:67], v[100:103], v[140:143], v[64:67]
    v_mfma_f32_16x16x32_bf16 v[68:71], v[100:103], v[172:175], v[68:71]
    v_mul_f32 v56, v56, v17
    v_mul_f32 v57, v57, v17
    v_mul_f32 v58, v58, v17
    v_mul_f32 v59, v59, v17
    v_mul_f32 v60, v60, v25
    v_mul_f32 v61, v61, v25
    v_mul_f32 v62, v62, v25
    v_mul_f32 v63, v63, v25
    v_cvt_pk_bf16_f32 v40, v56, v57
    v_cvt_pk_bf16_f32 v41, v58, v59
    v_cvt_pk_bf16_f32 v42, v60, v61
    v_cvt_pk_bf16_f32 v43, v62, v63
    s_nop 1
    v_permlane16_swap_b32 v40, v42
    v_permlane16_swap_b32 v41, v43
    s_nop 0
    buffer_store_dwordx4 v[40:43], v197, s[8:11], s32 offen sc1
    ds_read_b128 v[96:99], v5 offset:18432
    s_waitcnt lgkmcnt(6)
    v_mfma_f32_16x16x32_bf16 v[64:67], v[104:107], v[144:147], v[64:67]
    v_mfma_f32_16x16x32_bf16 v[68:71], v[104:107], v[176:179], v[68:71]
    ds_read_b128 v[100:103], v5 offset:19456
    s_waitcnt lgkmcnt(6)
    v_mfma_f32_16x16x32_bf16 v[64:67], v[108:111], v[148:151], v[64:67]
    v_mfma_f32_16x16x32_bf16 v[68:71], v[108:111], v[180:183], v[68:71]
    ds_read_b128 v[104:107], v5 offset:20480
    s_waitcnt lgkmcnt(6)
    v_mfma_f32_16x16x32_bf16 v[64:67], v[112:115], v[152:155], v[64:67]
    v_mfma_f32_16x16x32_bf16 v[68:71], v[112:115], v[184:187], v[68:71]
    ds_read_b128 v[108:111], v5 offset:21504
    s_waitcnt lgkmcnt(6)
    v_mfma_f32_16x16x32_bf16 v[64:67], v[116:119], v[156:159], v[64:67]
    v_mfma_f32_16x16x32_bf16 v[68:71], v[116:119], v[188:191], v[68:71]
    ds_read_b128 v[112:115], v5 offset:22528
    s_waitcnt lgkmcnt(6)
    v_mfma_f32_16x16x32_bf16 v[72:75], v[88:91], v[128:131], 0
    v_mfma_f32_16x16x32_bf16 v[76:79], v[88:91], v[160:163], 0
    ds_read_b128 v[116:119], v5 offset:23552
    s_waitcnt lgkmcnt(6)
    v_mfma_f32_16x16x32_bf16 v[72:75], v[92:95], v[132:135], v[72:75]
    v_mfma_f32_16x16x32_bf16 v[76:79], v[92:95], v[164:167], v[76:79]
    s_waitcnt lgkmcnt(5)
    v_mfma_f32_16x16x32_bf16 v[72:75], v[96:99], v[136:139], v[72:75]
    v_mfma_f32_16x16x32_bf16 v[76:79], v[96:99], v[168:171], v[76:79]
    s_waitcnt lgkmcnt(4)
    v_mfma_f32_16x16x32_bf16 v[72:75], v[100:103], v[140:143], v[72:75]
    v_mfma_f32_16x16x32_bf16 v[76:79], v[100:103], v[172:175], v[76:79]
    v_mul_f32 v64, v64, v17
    v_mul_f32 v65, v65, v17
    v_mul_f32 v66, v66, v17
    v_mul_f32 v67, v67, v17
    v_mul_f32 v68, v68, v25
    v_mul_f32 v69, v69, v25
    v_mul_f32 v70, v70, v25
    v_mul_f32 v71, v71, v25
    v_cvt_pk_bf16_f32 v44, v64, v65
    v_cvt_pk_bf16_f32 v45, v66, v67
    v_cvt_pk_bf16_f32 v46, v68, v69
    v_cvt_pk_bf16_f32 v47, v70, v71
    s_nop 1
    v_permlane16_swap_b32 v44, v46
    v_permlane16_swap_b32 v45, v47
    s_nop 0
    buffer_store_dwordx4 v[44:47], v197, s[8:11], s32 offen offset:512 sc1
    s_waitcnt lgkmcnt(3)
    v_mfma_f32_16x16x32_bf16 v[72:75], v[104:107], v[144:147], v[72:75]
    v_mfma_f32_16x16x32_bf16 v[76:79], v[104:107], v[176:179], v[76:79]
    s_waitcnt lgkmcnt(2)
    v_mfma_f32_16x16x32_bf16 v[72:75], v[108:111], v[148:151], v[72:75]
    v_mfma_f32_16x16x32_bf16 v[76:79], v[108:111], v[180:183], v[76:79]
    s_waitcnt lgkmcnt(1)
    v_mfma_f32_16x16x32_bf16 v[72:75], v[112:115], v[152:155], v[72:75]
    v_mfma_f32_16x16x32_bf16 v[76:79], v[112:115], v[184:187], v[76:79]
    s_waitcnt lgkmcnt(0)
    v_mfma_f32_16x16x32_bf16 v[72:75], v[116:119], v[156:159], v[72:75]
    v_mfma_f32_16x16x32_bf16 v[76:79], v[116:119], v[188:191], v[76:79]
    s_nop 7
    v_mul_f32 v72, v72, v17
    v_mul_f32 v73, v73, v17
    v_mul_f32 v74, v74, v17
    v_mul_f32 v75, v75, v17
    v_mul_f32 v76, v76, v25
    v_mul_f32 v77, v77, v25
    v_mul_f32 v78, v78, v25
    v_mul_f32 v79, v79, v25
    v_cvt_pk_bf16_f32 v48, v72, v73
    v_cvt_pk_bf16_f32 v49, v74, v75
    v_cvt_pk_bf16_f32 v50, v76, v77
    v_cvt_pk_bf16_f32 v51, v78, v79
    s_nop 1
    v_permlane16_swap_b32 v48, v50
    v_permlane16_swap_b32 v49, v51
    s_nop 0
    buffer_store_dwordx4 v[48:51], v197, s[8:11], s32 offen offset:1024 sc1
    s_lshl_b32 s35, s20, 4
    s_add_u32 s35, s35, s23
    s_lshl_b32 s35, s35, 6
    s_lshl_b32 s6, s21, 4
    s_add_u32 s35, s35, s6
    s_lshl_b32 s6, s22, 2
    s_add_u32 s35, s35, s6
    s_add_u32 s35, s35, 2048
    s_cmp_lg_u32 s30, 0
    s_cbranch_scc1 L_standalone__dit_block__diffusion_kernel_p2e
    v_add_f32 v120, v120, v18
    v_add_f32 v121, v121, v26
    v_cmp_eq_u32 vcc, 0, v3
    s_lshl_b32 s6, s22, 1
    s_add_u32 s6, s6, s21
    v_cndmask_b32 v120, v121, v120, vcc
    s_lshl_b32 s6, s6, 13
    s_lshl_b32 s7, s24, 6
    s_add_u32 s6, s6, s7
    s_add_u32 s6, s6, 0x10000
    v_lshrrev_b32 v5, 2, v4
    s_mov_b32 exec_hi, 0
    buffer_store_dword v120, v5, s[8:11], s6 offen sc1
    s_mov_b64 exec, -1
L_standalone__dit_block__diffusion_kernel_p2e:
    s_waitcnt vmcnt(0)
    s_barrier
    s_cmp_lg_u32 s3, 0
    s_cbranch_scc1 L_standalone__dit_block__diffusion_kernel_sg2
    v_mov_b32 v5, 0
    v_mov_b32 v6, 1
    s_lshl_b32 s35, s35, 5
    s_add_u32 s35, s35, 0x40000
    s_mov_b64 exec, 1
    buffer_store_dword v6, v5, s[8:11], s35 offen sc1
    s_mov_b64 exec, -1
L_standalone__dit_block__diffusion_kernel_sg2:
    s_lshl_b32 s51, s4, 1
    s_and_b32 s6, s5, 1
    s_add_u32 s51, s51, s6
    s_lshr_b32 s52, s5, 1
    s_lshl_b32 s53, s51, 3
    s_add_u32 s53, s53, s3
    s_lshr_b32 s25, s51, 3
    s_and_b32 s27, s3, 1
    s_mul_i32 s27, s27, 20480
    s_lshl_b32 s6, s3, 13
    s_add_u32 s6, s6, 40960
    s_cmp_lt_u32 s3, 4
    s_cselect_b32 s27, s6, s27
    s_mul_i32 s28, s52, 73728
    s_add_u32 s28, s28, s27
    s_mul_i32 s29, s25, 0x120000
    s_add_u32 s28, s28, s29
    s_add_u32 s28, s28, 0x300000
    s_add_u32 s27, s27, 24576
    s_lshr_b32 s6, s48, 5
    s_mul_i32 s31, s6, 9216
    s_lshl_b32 s6, s50, 6
    s_add_u32 s31, s31, s6
    s_add_u32 s31, s31, 3072
    v_lshlrev_b32 v7, 4, v3
    buffer_load_dwordx4 v[252:255], v7, s[8:11], s31 offen sc1
    s_cmp_ge_u32 s3, 4
    s_cbranch_scc1 L_standalone__dit_block__diffusion_kernel_p4z
    s_mov_b32 s39, 2
L_standalone__dit_block__diffusion_kernel_p4l:
    s_mov_b32 m0, s27
    s_add_u32 s27, s27, 4096
    buffer_load_dwordx4 v4, s[8:11], s28 offen sc1 lds
    buffer_load_dwordx4 v4, s[8:11], s28 offen offset:1024 sc1 lds
    buffer_load_dwordx4 v4, s[8:11], s28 offen offset:2048 sc1 lds
    buffer_load_dwordx4 v4, s[8:11], s28 offen offset:3072 sc1 lds
    s_add_u32 s28, s28, 4096
    s_sub_u32 s39, s39, 1
    s_cmp_lg_u32 s39, 0
    s_cbranch_scc1 L_standalone__dit_block__diffusion_kernel_p4l
L_standalone__dit_block__diffusion_kernel_p4z:
    s_lshl_b32 s54, s4, 2
    s_and_b32 s6, s5, 3
    s_add_u32 s54, s54, s6
    s_lshr_b32 s55, s5, 2
    s_lshl_b32 s56, s54, 2
    s_and_b32 s6, s3, 3
    s_add_u32 s56, s56, s6
    s_mul_i32 s57, s55, 147456
    s_and_b32 s6, s3, 1
    s_mul_i32 s6, s6, 24576
    s_add_u32 s57, s57, s6
    s_lshr_b32 s6, s3, 1
    s_lshl_b32 s6, s6, 10
    s_add_u32 s57, s57, s6
    s_add_u32 s57, s57, 0x180000
    s_mul_i32 s38, s3, 3072
    s_lshr_b32 s25, s51, 3
    s_mul_i32 s30, s25, 12288
    s_mul_i32 s31, s52, 384
    s_add_u32 s30, s30, s31
    s_add_u32 s30, s30, 0x8000
    v_cmp_le_u32 vcc, 384, v4
    v_add_u32 v6, 5760, v4
    s_mov_b32 m0, 159744
    v_cndmask_b32 v6, v4, v6, vcc
    s_cmp_lg_u32 s3, 0
    s_cbranch_scc1 L_standalone__dit_block__diffusion_kernel_uv
    buffer_load_dwordx4 v6, s[8:11], s30 offen sc1 lds
L_standalone__dit_block__diffusion_kernel_uv:
    v_add_u32 v168, 0, v4
    v_add_u32 v169, 49152, v4
    v_add_u32 v170, 98304, v4
    s_lshl_b32 s22, s48, 1
    s_lshr_b32 s6, s3, 2
    s_add_u32 s23, s22, s6
    s_and_b32 s24, s3, 3
    s_mul_i32 s25, s23, 12288
    s_mul_i32 s6, s24, 3072
    s_add_u32 s25, s25, s6
    s_add_u32 s25, s25, 0xb00000
    s_lshr_b32 s6, s24, 1
    s_lshl_b32 s26, s6, 13
    s_lshl_b32 s6, s23, 6
    s_add_u32 s26, s26, s6
    s_add_u32 s26, s26, 0x10000
    s_cmp_lg_u32 s3, 7
    s_cbranch_scc1 L_standalone__dit_block__diffusion_kernel_pd3
    s_lshr_b32 s6, s48, 1
    s_lshl_b32 s6, s6, 6
    s_add_u32 s6, s6, 2048
    v_and_b32 v5, 7, v0
    v_lshlrev_b32 v5, 2, v5
    v_add_u32 v5, s6, v5
    v_lshlrev_b32 v5, 5, v5
    s_mov_b32 s6, 0x40000
    s_mov_b32 s7, 0
L_standalone__dit_block__diffusion_kernel_pl3:
    buffer_load_dword v6, v5, s[8:11], s6 offen sc1
    s_waitcnt vmcnt(0)
    v_cmp_eq_u32 vcc, 0, v6
    s_add_u32 s7, s7, 1
    s_cmp_ge_u32 s7, 0x10000
    s_cbranch_scc1 L_standalone__dit_block__diffusion_kernel_pd3
    s_nop 2
    s_cbranch_vccz L_standalone__dit_block__diffusion_kernel_pd3
    s_sleep 3
    s_branch L_standalone__dit_block__diffusion_kernel_pl3
L_standalone__dit_block__diffusion_kernel_pd3:
    s_barrier
    v_lshlrev_b32 v5, 2, v2
    buffer_load_dword v56, v5, s[8:11], s26 offen sc1
    s_add_u32 s26, s26, 16384
    buffer_load_dword v57, v5, s[8:11], s26 offen sc1
    s_add_u32 s26, s26, 16384
    buffer_load_dword v58, v5, s[8:11], s26 offen sc1
    s_add_u32 s26, s26, 16384
    buffer_load_dword v59, v5, s[8:11], s26 offen sc1
    s_add_u32 s6, s25, 0x0
    buffer_load_dwordx4 v[8:11], v4, s[8:11], s6 offen sc1
    s_add_u32 s6, s25, 0x180000
    buffer_load_dwordx4 v[12:15], v4, s[8:11], s6 offen sc1
    s_add_u32 s6, s25, 0x300000
    buffer_load_dwordx4 v[16:19], v4, s[8:11], s6 offen sc1
    s_add_u32 s6, s25, 0x480000
    buffer_load_dwordx4 v[20:23], v4, s[8:11], s6 offen sc1
    s_add_u32 s6, s25, 0x0
    buffer_load_dwordx4 v[24:27], v4, s[8:11], s6 offen offset:1024 sc1
    s_add_u32 s6, s25, 0x180000
    buffer_load_dwordx4 v[28:31], v4, s[8:11], s6 offen offset:1024 sc1
    s_add_u32 s6, s25, 0x300000
    buffer_load_dwordx4 v[32:35], v4, s[8:11], s6 offen offset:1024 sc1
    s_add_u32 s6, s25, 0x480000
    buffer_load_dwordx4 v[36:39], v4, s[8:11], s6 offen offset:1024 sc1
    s_add_u32 s6, s25, 0x0
    buffer_load_dwordx4 v[40:43], v4, s[8:11], s6 offen offset:2048 sc1
    s_add_u32 s6, s25, 0x180000
    buffer_load_dwordx4 v[44:47], v4, s[8:11], s6 offen offset:2048 sc1
    s_add_u32 s6, s25, 0x300000
    buffer_load_dwordx4 v[48:51], v4, s[8:11], s6 offen offset:2048 sc1
    s_add_u32 s6, s25, 0x480000
    buffer_load_dwordx4 v[52:55], v4, s[8:11], s6 offen offset:2048 sc1
    s_waitcnt vmcnt(12)
    v_max3_f32 v104, v56, v57, v58
    v_max_f32 v104, v104, v59
    v_sub_f32 v56, v56, v104
    v_sub_f32 v57, v57, v104
    v_sub_f32 v58, v58, v104
    v_sub_f32 v59, v59, v104
    v_exp_f32 v56, v56
    v_exp_f32 v57, v57
    v_exp_f32 v58, v58
    v_exp_f32 v59, v59
    s_nop 0
    v_add_f32 v104, v56, v57
    v_add_f32 v104, v104, v58
    v_add_f32 v104, v104, v59
    v_rcp_f32 v104, v104
    s_mul_i32 s6, s3, 3072
    v_mul_f32 v56, v56, v104
    v_mul_f32 v57, v57, v104
    v_mul_f32 v58, v58, v104
    v_mul_f32 v59, v59, v104
    v_add_u32 v5, s6, v4
    s_waitcnt vmcnt(11)
    v_lshlrev_b32 v60, 16, v8
    v_and_b32 v61, 0xffff0000, v8
    v_lshlrev_b32 v62, 16, v9
    v_and_b32 v63, 0xffff0000, v9
    v_lshlrev_b32 v64, 16, v10
    v_and_b32 v65, 0xffff0000, v10
    v_lshlrev_b32 v66, 16, v11
    v_and_b32 v67, 0xffff0000, v11
    v_pk_mul_f32 v[104:105], v[60:61], v[56:57] op_sel:[0,0] op_sel_hi:[1,0]
    v_pk_mul_f32 v[106:107], v[62:63], v[56:57] op_sel:[0,0] op_sel_hi:[1,0]
    v_pk_mul_f32 v[108:109], v[64:65], v[56:57] op_sel:[0,0] op_sel_hi:[1,0]
    v_pk_mul_f32 v[110:111], v[66:67], v[56:57] op_sel:[0,0] op_sel_hi:[1,0]
    s_waitcnt vmcnt(10)
    v_lshlrev_b32 v60, 16, v12
    v_and_b32 v61, 0xffff0000, v12
    v_lshlrev_b32 v62, 16, v13
    v_and_b32 v63, 0xffff0000, v13
    v_lshlrev_b32 v64, 16, v14
    v_and_b32 v65, 0xffff0000, v14
    v_lshlrev_b32 v66, 16, v15
    v_and_b32 v67, 0xffff0000, v15
    v_pk_fma_f32 v[104:105], v[60:61], v[56:57], v[104:105] op_sel:[0,1,0] op_sel_hi:[1,1,1]
    v_pk_fma_f32 v[106:107], v[62:63], v[56:57], v[106:107] op_sel:[0,1,0] op_sel_hi:[1,1,1]
    v_pk_fma_f32 v[108:109], v[64:65], v[56:57], v[108:109] op_sel:[0,1,0] op_sel_hi:[1,1,1]
    v_pk_fma_f32 v[110:111], v[66:67], v[56:57], v[110:111] op_sel:[0,1,0] op_sel_hi:[1,1,1]
    s_waitcnt vmcnt(9)
    v_lshlrev_b32 v60, 16, v16
    v_and_b32 v61, 0xffff0000, v16
    v_lshlrev_b32 v62, 16, v17
    v_and_b32 v63, 0xffff0000, v17
    v_lshlrev_b32 v64, 16, v18
    v_and_b32 v65, 0xffff0000, v18
    v_lshlrev_b32 v66, 16, v19
    v_and_b32 v67, 0xffff0000, v19
    v_pk_fma_f32 v[104:105], v[60:61], v[58:59], v[104:105] op_sel:[0,0,0] op_sel_hi:[1,0,1]
    v_pk_fma_f32 v[106:107], v[62:63], v[58:59], v[106:107] op_sel:[0,0,0] op_sel_hi:[1,0,1]
    v_pk_fma_f32 v[108:109], v[64:65], v[58:59], v[108:109] op_sel:[0,0,0] op_sel_hi:[1,0,1]
    v_pk_fma_f32 v[110:111], v[66:67], v[58:59], v[110:111] op_sel:[0,0,0] op_sel_hi:[1,0,1]
    s_waitcnt vmcnt(8)
    v_lshlrev_b32 v60, 16, v20
    v_and_b32 v61, 0xffff0000, v20
    v_lshlrev_b32 v62, 16, v21
    v_and_b32 v63, 0xffff0000, v21
    v_lshlrev_b32 v64, 16, v22
    v_and_b32 v65, 0xffff0000, v22
    v_lshlrev_b32 v66, 16, v23
    v_and_b32 v67, 0xffff0000, v23
    v_pk_fma_f32 v[104:105], v[60:61], v[58:59], v[104:105] op_sel:[0,1,0] op_sel_hi:[1,1,1]
    v_pk_fma_f32 v[106:107], v[62:63], v[58:59], v[106:107] op_sel:[0,1,0] op_sel_hi:[1,1,1]
    v_pk_fma_f32 v[108:109], v[64:65], v[58:59], v[108:109] op_sel:[0,1,0] op_sel_hi:[1,1,1]
    v_pk_fma_f32 v[110:111], v[66:67], v[58:59], v[110:111] op_sel:[0,1,0] op_sel_hi:[1,1,1]
    v_cvt_pk_bf16_f32 v8, v104, v105
    v_cvt_pk_bf16_f32 v9, v106, v107
    v_cvt_pk_bf16_f32 v10, v108, v109
    v_cvt_pk_bf16_f32 v11, v110, v111
    ds_write_b128 v5, v[8:11] offset:0
    s_waitcnt vmcnt(7)
    v_lshlrev_b32 v60, 16, v24
    v_and_b32 v61, 0xffff0000, v24
    v_lshlrev_b32 v62, 16, v25
    v_and_b32 v63, 0xffff0000, v25
    v_lshlrev_b32 v64, 16, v26
    v_and_b32 v65, 0xffff0000, v26
    v_lshlrev_b32 v66, 16, v27
    v_and_b32 v67, 0xffff0000, v27
    v_pk_mul_f32 v[104:105], v[60:61], v[56:57] op_sel:[0,0] op_sel_hi:[1,0]
    v_pk_mul_f32 v[106:107], v[62:63], v[56:57] op_sel:[0,0] op_sel_hi:[1,0]
    v_pk_mul_f32 v[108:109], v[64:65], v[56:57] op_sel:[0,0] op_sel_hi:[1,0]
    v_pk_mul_f32 v[110:111], v[66:67], v[56:57] op_sel:[0,0] op_sel_hi:[1,0]
    s_waitcnt vmcnt(6)
    v_lshlrev_b32 v60, 16, v28
    v_and_b32 v61, 0xffff0000, v28
    v_lshlrev_b32 v62, 16, v29
    v_and_b32 v63, 0xffff0000, v29
    v_lshlrev_b32 v64, 16, v30
    v_and_b32 v65, 0xffff0000, v30
    v_lshlrev_b32 v66, 16, v31
    v_and_b32 v67, 0xffff0000, v31
    v_pk_fma_f32 v[104:105], v[60:61], v[56:57], v[104:105] op_sel:[0,1,0] op_sel_hi:[1,1,1]
    v_pk_fma_f32 v[106:107], v[62:63], v[56:57], v[106:107] op_sel:[0,1,0] op_sel_hi:[1,1,1]
    v_pk_fma_f32 v[108:109], v[64:65], v[56:57], v[108:109] op_sel:[0,1,0] op_sel_hi:[1,1,1]
    v_pk_fma_f32 v[110:111], v[66:67], v[56:57], v[110:111] op_sel:[0,1,0] op_sel_hi:[1,1,1]
    s_waitcnt vmcnt(5)
    v_lshlrev_b32 v60, 16, v32
    v_and_b32 v61, 0xffff0000, v32
    v_lshlrev_b32 v62, 16, v33
    v_and_b32 v63, 0xffff0000, v33
    v_lshlrev_b32 v64, 16, v34
    v_and_b32 v65, 0xffff0000, v34
    v_lshlrev_b32 v66, 16, v35
    v_and_b32 v67, 0xffff0000, v35
    v_pk_fma_f32 v[104:105], v[60:61], v[58:59], v[104:105] op_sel:[0,0,0] op_sel_hi:[1,0,1]
    v_pk_fma_f32 v[106:107], v[62:63], v[58:59], v[106:107] op_sel:[0,0,0] op_sel_hi:[1,0,1]
    v_pk_fma_f32 v[108:109], v[64:65], v[58:59], v[108:109] op_sel:[0,0,0] op_sel_hi:[1,0,1]
    v_pk_fma_f32 v[110:111], v[66:67], v[58:59], v[110:111] op_sel:[0,0,0] op_sel_hi:[1,0,1]
    s_waitcnt vmcnt(4)
    v_lshlrev_b32 v60, 16, v36
    v_and_b32 v61, 0xffff0000, v36
    v_lshlrev_b32 v62, 16, v37
    v_and_b32 v63, 0xffff0000, v37
    v_lshlrev_b32 v64, 16, v38
    v_and_b32 v65, 0xffff0000, v38
    v_lshlrev_b32 v66, 16, v39
    v_and_b32 v67, 0xffff0000, v39
    v_pk_fma_f32 v[104:105], v[60:61], v[58:59], v[104:105] op_sel:[0,1,0] op_sel_hi:[1,1,1]
    v_pk_fma_f32 v[106:107], v[62:63], v[58:59], v[106:107] op_sel:[0,1,0] op_sel_hi:[1,1,1]
    v_pk_fma_f32 v[108:109], v[64:65], v[58:59], v[108:109] op_sel:[0,1,0] op_sel_hi:[1,1,1]
    v_pk_fma_f32 v[110:111], v[66:67], v[58:59], v[110:111] op_sel:[0,1,0] op_sel_hi:[1,1,1]
    v_cvt_pk_bf16_f32 v24, v104, v105
    v_cvt_pk_bf16_f32 v25, v106, v107
    v_cvt_pk_bf16_f32 v26, v108, v109
    v_cvt_pk_bf16_f32 v27, v110, v111
    ds_write_b128 v5, v[24:27] offset:1024
    s_waitcnt vmcnt(3)
    v_lshlrev_b32 v60, 16, v40
    v_and_b32 v61, 0xffff0000, v40
    v_lshlrev_b32 v62, 16, v41
    v_and_b32 v63, 0xffff0000, v41
    v_lshlrev_b32 v64, 16, v42
    v_and_b32 v65, 0xffff0000, v42
    v_lshlrev_b32 v66, 16, v43
    v_and_b32 v67, 0xffff0000, v43
    v_pk_mul_f32 v[104:105], v[60:61], v[56:57] op_sel:[0,0] op_sel_hi:[1,0]
    v_pk_mul_f32 v[106:107], v[62:63], v[56:57] op_sel:[0,0] op_sel_hi:[1,0]
    v_pk_mul_f32 v[108:109], v[64:65], v[56:57] op_sel:[0,0] op_sel_hi:[1,0]
    v_pk_mul_f32 v[110:111], v[66:67], v[56:57] op_sel:[0,0] op_sel_hi:[1,0]
    s_waitcnt vmcnt(2)
    v_lshlrev_b32 v60, 16, v44
    v_and_b32 v61, 0xffff0000, v44
    v_lshlrev_b32 v62, 16, v45
    v_and_b32 v63, 0xffff0000, v45
    v_lshlrev_b32 v64, 16, v46
    v_and_b32 v65, 0xffff0000, v46
    v_lshlrev_b32 v66, 16, v47
    v_and_b32 v67, 0xffff0000, v47
    v_pk_fma_f32 v[104:105], v[60:61], v[56:57], v[104:105] op_sel:[0,1,0] op_sel_hi:[1,1,1]
    v_pk_fma_f32 v[106:107], v[62:63], v[56:57], v[106:107] op_sel:[0,1,0] op_sel_hi:[1,1,1]
    v_pk_fma_f32 v[108:109], v[64:65], v[56:57], v[108:109] op_sel:[0,1,0] op_sel_hi:[1,1,1]
    v_pk_fma_f32 v[110:111], v[66:67], v[56:57], v[110:111] op_sel:[0,1,0] op_sel_hi:[1,1,1]
    s_waitcnt vmcnt(1)
    v_lshlrev_b32 v60, 16, v48
    v_and_b32 v61, 0xffff0000, v48
    v_lshlrev_b32 v62, 16, v49
    v_and_b32 v63, 0xffff0000, v49
    v_lshlrev_b32 v64, 16, v50
    v_and_b32 v65, 0xffff0000, v50
    v_lshlrev_b32 v66, 16, v51
    v_and_b32 v67, 0xffff0000, v51
    v_pk_fma_f32 v[104:105], v[60:61], v[58:59], v[104:105] op_sel:[0,0,0] op_sel_hi:[1,0,1]
    v_pk_fma_f32 v[106:107], v[62:63], v[58:59], v[106:107] op_sel:[0,0,0] op_sel_hi:[1,0,1]
    v_pk_fma_f32 v[108:109], v[64:65], v[58:59], v[108:109] op_sel:[0,0,0] op_sel_hi:[1,0,1]
    v_pk_fma_f32 v[110:111], v[66:67], v[58:59], v[110:111] op_sel:[0,0,0] op_sel_hi:[1,0,1]
    s_waitcnt vmcnt(0)
    v_lshlrev_b32 v60, 16, v52
    v_and_b32 v61, 0xffff0000, v52
    v_lshlrev_b32 v62, 16, v53
    v_and_b32 v63, 0xffff0000, v53
    v_lshlrev_b32 v64, 16, v54
    v_and_b32 v65, 0xffff0000, v54
    v_lshlrev_b32 v66, 16, v55
    v_and_b32 v67, 0xffff0000, v55
    v_pk_fma_f32 v[104:105], v[60:61], v[58:59], v[104:105] op_sel:[0,1,0] op_sel_hi:[1,1,1]
    v_pk_fma_f32 v[106:107], v[62:63], v[58:59], v[106:107] op_sel:[0,1,0] op_sel_hi:[1,1,1]
    v_pk_fma_f32 v[108:109], v[64:65], v[58:59], v[108:109] op_sel:[0,1,0] op_sel_hi:[1,1,1]
    v_pk_fma_f32 v[110:111], v[66:67], v[58:59], v[110:111] op_sel:[0,1,0] op_sel_hi:[1,1,1]
    v_cvt_pk_bf16_f32 v40, v104, v105
    v_cvt_pk_bf16_f32 v41, v106, v107
    v_cvt_pk_bf16_f32 v42, v108, v109
    v_cvt_pk_bf16_f32 v43, v110, v111
    ds_write_b128 v5, v[40:43] offset:2048
    s_lshr_b32 s35, s48, 2
    s_lshl_b32 s35, s35, 6
    s_and_b32 s6, s48, 3
    s_lshl_b32 s6, s6, 4
    s_add_u32 s35, s35, s6
    s_lshl_b32 s6, s49, 2
    s_add_u32 s35, s35, s6
    s_add_u32 s35, s35, 4096
    s_waitcnt lgkmcnt(0)
    s_barrier
    s_cmp_ge_u32 s3, 6
    s_cbranch_scc1 L_standalone__dit_block__diffusion_kernel_p3d
    ds_read_b128 v[8:11], v4 offset:0
    ds_read_b128 v[12:15], v4 offset:12288
    ds_read_b128 v[16:19], v4 offset:1024
    ds_read_b128 v[20:23], v4 offset:13312
    ds_read_b128 v[24:27], v4 offset:2048
    ds_read_b128 v[28:31], v4 offset:14336
    ds_read_b128 v[32:35], v4 offset:3072
    ds_read_b128 v[36:39], v4 offset:15360
    ds_read_b128 v[40:43], v4 offset:4096
    ds_read_b128 v[44:47], v4 offset:16384
    ds_read_b128 v[48:51], v4 offset:5120
    ds_read_b128 v[52:55], v4 offset:17408
    s_waitcnt lgkmcnt(11)
    v_mfma_f32_16x16x32_bf16 v[104:107], v[200:203], v[8:11], 0
    ds_read_b128 v[8:11], v4 offset:6144
    s_waitcnt lgkmcnt(11)
    v_mfma_f32_16x16x32_bf16 v[108:111], v[200:203], v[12:15], 0
    ds_read_b128 v[12:15], v4 offset:18432
    s_waitcnt lgkmcnt(11)
    v_mfma_f32_16x16x32_bf16 v[104:107], v[204:207], v[16:19], v[104:107]
    ds_read_b128 v[16:19], v4 offset:7168
    s_waitcnt lgkmcnt(11)
    v_mfma_f32_16x16x32_bf16 v[108:111], v[204:207], v[20:23], v[108:111]
    ds_read_b128 v[20:23], v4 offset:19456
    s_waitcnt lgkmcnt(11)
    v_mfma_f32_16x16x32_bf16 v[104:107], v[208:211], v[24:27], v[104:107]
    ds_read_b128 v[24:27], v4 offset:8192
    s_waitcnt lgkmcnt(11)
    v_mfma_f32_16x16x32_bf16 v[108:111], v[208:211], v[28:31], v[108:111]
    ds_read_b128 v[28:31], v4 offset:20480
    s_waitcnt lgkmcnt(11)
    v_mfma_f32_16x16x32_bf16 v[104:107], v[212:215], v[32:35], v[104:107]
    ds_read_b128 v[32:35], v4 offset:9216
    s_waitcnt lgkmcnt(11)
    v_mfma_f32_16x16x32_bf16 v[108:111], v[212:215], v[36:39], v[108:111]
    ds_read_b128 v[36:39], v4 offset:21504
    s_waitcnt lgkmcnt(11)
    v_mfma_f32_16x16x32_bf16 v[104:107], v[216:219], v[40:43], v[104:107]
    ds_read_b128 v[40:43], v4 offset:10240
    s_waitcnt lgkmcnt(11)
    v_mfma_f32_16x16x32_bf16 v[108:111], v[216:219], v[44:47], v[108:111]
    ds_read_b128 v[44:47], v4 offset:22528
    s_waitcnt lgkmcnt(11)
    v_mfma_f32_16x16x32_bf16 v[104:107], v[220:223], v[48:51], v[104:107]
    ds_read_b128 v[48:51], v4 offset:11264
    s_waitcnt lgkmcnt(11)
    v_mfma_f32_16x16x32_bf16 v[108:111], v[220:223], v[52:55], v[108:111]
    ds_read_b128 v[52:55], v4 offset:23552
    s_waitcnt lgkmcnt(11)
    v_mfma_f32_16x16x32_bf16 v[104:107], v[224:227], v[8:11], v[104:107]
    s_waitcnt lgkmcnt(10)
    v_mfma_f32_16x16x32_bf16 v[108:111], v[224:227], v[12:15], v[108:111]
    s_waitcnt lgkmcnt(9)
    v_mfma_f32_16x16x32_bf16 v[104:107], v[228:231], v[16:19], v[104:107]
    s_waitcnt lgkmcnt(8)
    v_mfma_f32_16x16x32_bf16 v[108:111], v[228:231], v[20:23], v[108:111]
    s_waitcnt lgkmcnt(7)
    v_mfma_f32_16x16x32_bf16 v[104:107], v[232:235], v[24:27], v[104:107]
    s_waitcnt lgkmcnt(6)
    v_mfma_f32_16x16x32_bf16 v[108:111], v[232:235], v[28:31], v[108:111]
    s_waitcnt lgkmcnt(5)
    v_mfma_f32_16x16x32_bf16 v[104:107], v[236:239], v[32:35], v[104:107]
    s_waitcnt lgkmcnt(4)
    v_mfma_f32_16x16x32_bf16 v[108:111], v[236:239], v[36:39], v[108:111]
    s_waitcnt lgkmcnt(3)
    v_mfma_f32_16x16x32_bf16 v[104:107], v[240:243], v[40:43], v[104:107]
    s_waitcnt lgkmcnt(2)
    v_mfma_f32_16x16x32_bf16 v[108:111], v[240:243], v[44:47], v[108:111]
    s_waitcnt lgkmcnt(1)
    v_mfma_f32_16x16x32_bf16 v[104:107], v[244:247], v[48:51], v[104:107]
    s_waitcnt lgkmcnt(0)
    v_mfma_f32_16x16x32_bf16 v[108:111], v[244:247], v[52:55], v[108:111]
    s_mul_i32 s32, s22, 12288
    s_lshl_b32 s6, s50, 9
    s_add_u32 s32, s32, s6
    s_add_u32 s32, s32, 0x1100000
    v_and_b32 v5, 1, v3
    v_mul_u32_u24 v5, 12288, v5
    v_lshrrev_b32 v6, 1, v3
    v_lshl_add_u32 v5, v6, 8, v5
    v_lshl_add_u32 v5, v2, 4, v5
    v_lshlrev_b32 v8, 16, v248
    v_and_b32 v9, 0xffff0000, v248
    v_fma_f32 v104, v104, v252, v8
    v_fma_f32 v105, v105, v253, v9
    v_lshlrev_b32 v8, 16, v249
    v_and_b32 v9, 0xffff0000, v249
    v_fma_f32 v106, v106, v254, v8
    v_fma_f32 v107, v107, v255, v9
    v_lshlrev_b32 v8, 16, v250
    v_and_b32 v9, 0xffff0000, v250
    v_fma_f32 v108, v108, v252, v8
    v_fma_f32 v109, v109, v253, v9
    v_lshlrev_b32 v8, 16, v251
    v_and_b32 v9, 0xffff0000, v251
    v_fma_f32 v110, v110, v254, v8
    v_fma_f32 v111, v111, v255, v9
    v_cvt_pk_bf16_f32 v12, v104, v105
    v_cvt_pk_bf16_f32 v13, v106, v107
    v_cvt_pk_bf16_f32 v14, v108, v109
    v_cvt_pk_bf16_f32 v15, v110, v111
    s_nop 1
    v_permlane16_swap_b32 v12, v14
    v_permlane16_swap_b32 v13, v15
    s_nop 0
    buffer_store_dwordx4 v[12:15], v5, s[8:11], s32 offen sc1
    s_waitcnt vmcnt(0)
    s_branch L_standalone__dit_block__diffusion_kernel_p3e
L_standalone__dit_block__diffusion_kernel_p3d:
    s_mov_b32 s39, 5
L_standalone__dit_block__diffusion_kernel_p3l:
    s_mov_b32 m0, s27
    s_add_u32 s27, s27, 4096
    buffer_load_dwordx4 v4, s[8:11], s28 offen sc1 lds
    buffer_load_dwordx4 v4, s[8:11], s28 offen offset:1024 sc1 lds
    buffer_load_dwordx4 v4, s[8:11], s28 offen offset:2048 sc1 lds
    buffer_load_dwordx4 v4, s[8:11], s28 offen offset:3072 sc1 lds
    s_add_u32 s28, s28, 4096
    s_sub_u32 s39, s39, 1
    s_cmp_lg_u32 s39, 0
    s_cbranch_scc1 L_standalone__dit_block__diffusion_kernel_p3l
L_standalone__dit_block__diffusion_kernel_p3e:
    s_waitcnt vmcnt(63)
    s_barrier
    s_cmp_lg_u32 s3, 0
    s_cbranch_scc1 L_standalone__dit_block__diffusion_kernel_sg3
    v_mov_b32 v5, 0
    v_mov_b32 v6, 1
    s_lshl_b32 s35, s35, 5
    s_add_u32 s35, s35, 0x40000
    s_mov_b64 exec, 1
    buffer_store_dword v6, v5, s[8:11], s35 offen sc1
    s_mov_b64 exec, -1
L_standalone__dit_block__diffusion_kernel_sg3:
    s_mul_i32 s23, s53, 12288
    s_add_u32 s23, s23, 0x1100000
    s_cmp_lg_u32 s3, 1
    s_cbranch_scc1 L_standalone__dit_block__diffusion_kernel_pd4
    s_lshl_b32 s6, s51, 6
    s_add_u32 s6, s6, 4096
    v_lshlrev_b32 v5, 2, v2
    v_add_u32 v5, s6, v5
    v_lshlrev_b32 v5, 5, v5
    s_mov_b32 s6, 0x40000
    s_mov_b32 s7, 0
L_standalone__dit_block__diffusion_kernel_pl4:
    buffer_load_dword v6, v5, s[8:11], s6 offen sc1
    s_waitcnt vmcnt(0)
    v_cmp_eq_u32 vcc, 0, v6
    s_add_u32 s7, s7, 1
    s_cmp_ge_u32 s7, 0x10000
    s_cbranch_scc1 L_standalone__dit_block__diffusion_kernel_pd4
    s_nop 2
    s_cbranch_vccz L_standalone__dit_block__diffusion_kernel_pd4
    s_sleep 3
    s_branch L_standalone__dit_block__diffusion_kernel_pl4
L_standalone__dit_block__diffusion_kernel_pd4:
    s_waitcnt vmcnt(0)
    s_barrier
    buffer_load_dwordx4 v[8:11], v4, s[8:11], s23 offen sc1
    buffer_load_dwordx4 v[12:15], v4, s[8:11], s23 offen offset:1024 sc1
    buffer_load_dwordx4 v[16:19], v4, s[8:11], s23 offen offset:2048 sc1
    buffer_load_dwordx4 v[20:23], v4, s[8:11], s23 offen offset:3072 sc1
    s_add_u32 s23, s23, 4096
    buffer_load_dwordx4 v[24:27], v4, s[8:11], s23 offen sc1
    buffer_load_dwordx4 v[28:31], v4, s[8:11], s23 offen offset:1024 sc1
    buffer_load_dwordx4 v[32:35], v4, s[8:11], s23 offen offset:2048 sc1
    buffer_load_dwordx4 v[36:39], v4, s[8:11], s23 offen offset:3072 sc1
    s_add_u32 s23, s23, 4096
    buffer_load_dwordx4 v[40:43], v4, s[8:11], s23 offen sc1
    buffer_load_dwordx4 v[44:47], v4, s[8:11], s23 offen offset:1024 sc1
    buffer_load_dwordx4 v[48:51], v4, s[8:11], s23 offen offset:2048 sc1
    buffer_load_dwordx4 v[52:55], v4, s[8:11], s23 offen offset:3072 sc1
    v_add_u32 v6, 24576, v4
    v_add_u32 v7, 61440, v4
    s_mul_i32 s32, s53, 48
    s_mul_i32 s33, s52, 3
    s_add_u32 s32, s32, s33
    s_lshl_b32 s32, s32, 10
    s_add_u32 s32, s32, 0x1300000
    v_mov_b32 v86, 1.0
    v_mov_b32 v84, 0xbdd2d3e8
    v_mov_b32 v85, 0xc0135761
    s_lshl_b32 s35, s51, 6
    s_lshl_b32 s6, s52, 2
    s_add_u32 s35, s35, s6
    s_add_u32 s35, s35, 5120
    v_lshlrev_b32 v1, 4, v3
    v_add_u32 v1, 159744, v1
    v_mov_b32 v192, 0x3f803f80
    v_mov_b32 v193, 0x3f803f80
    v_mov_b32 v194, 0x3f803f80
    v_mov_b32 v195, 0x3f803f80
    ds_read_b128 v[200:203], v1 offset:0
    ds_read_b128 v[224:227], v1 offset:384
    ds_read_b128 v[204:207], v1 offset:64
    ds_read_b128 v[228:231], v1 offset:448
    ds_read_b128 v[208:211], v1 offset:128
    ds_read_b128 v[232:235], v1 offset:512
    ds_read_b128 v[212:215], v1 offset:192
    ds_read_b128 v[236:239], v1 offset:576
    ds_read_b128 v[216:219], v1 offset:256
    ds_read_b128 v[240:243], v1 offset:640
    ds_read_b128 v[220:223], v1 offset:320
    ds_read_b128 v[244:247], v1 offset:704
    s_waitcnt lgkmcnt(0)
    ds_read_b128 v[128:131], v6 offset:0
    ds_read_b128 v[132:135], v6 offset:12288
    ds_read_b128 v[136:139], v6 offset:24576
    ds_read_b128 v[140:143], v7 offset:0
    ds_read_b128 v[144:147], v6 offset:1024
    ds_read_b128 v[148:151], v6 offset:13312
    ds_read_b128 v[152:155], v6 offset:25600
    ds_read_b128 v[156:159], v7 offset:1024
    s_waitcnt lgkmcnt(7)
    s_waitcnt vmcnt(11)
    v_mfma_f32_16x16x32_bf16 v[104:107], v[128:131], v[8:11], 0
    v_mfma_f32_16x16x32_bf16 v[184:187], v[192:195], v[8:11], 0
    v_mfma_f32_16x16x32_bf16 v[188:191], v[8:11], v[8:11], 0
    ds_read_b128 v[128:131], v6 offset:2048
    s_waitcnt lgkmcnt(7)
    v_mfma_f32_16x16x32_bf16 v[108:111], v[132:135], v[8:11], 0
    ds_read_b128 v[132:135], v6 offset:14336
    s_waitcnt lgkmcnt(7)
    v_mfma_f32_16x16x32_bf16 v[112:115], v[136:139], v[8:11], 0
    ds_read_b128 v[136:139], v6 offset:26624
    s_waitcnt lgkmcnt(7)
    v_mfma_f32_16x16x32_bf16 v[116:119], v[140:143], v[8:11], 0
    ds_read_b128 v[140:143], v7 offset:2048
    s_waitcnt lgkmcnt(7)
    s_waitcnt vmcnt(10)
    v_mfma_f32_16x16x32_bf16 v[104:107], v[144:147], v[12:15], v[104:107]
    v_mfma_f32_16x16x32_bf16 v[184:187], v[192:195], v[12:15], v[184:187]
    v_mfma_f32_16x16x32_bf16 v[188:191], v[12:15], v[12:15], v[188:191]
    ds_read_b128 v[144:147], v6 offset:3072
    s_waitcnt lgkmcnt(7)
    v_mfma_f32_16x16x32_bf16 v[108:111], v[148:151], v[12:15], v[108:111]
    ds_read_b128 v[148:151], v6 offset:15360
    s_waitcnt lgkmcnt(7)
    v_mfma_f32_16x16x32_bf16 v[112:115], v[152:155], v[12:15], v[112:115]
    ds_read_b128 v[152:155], v6 offset:27648
    s_waitcnt lgkmcnt(7)
    v_mfma_f32_16x16x32_bf16 v[116:119], v[156:159], v[12:15], v[116:119]
    ds_read_b128 v[156:159], v7 offset:3072
    s_waitcnt lgkmcnt(7)
    s_waitcnt vmcnt(9)
    v_mfma_f32_16x16x32_bf16 v[104:107], v[128:131], v[16:19], v[104:107]
    v_mfma_f32_16x16x32_bf16 v[184:187], v[192:195], v[16:19], v[184:187]
    v_mfma_f32_16x16x32_bf16 v[188:191], v[16:19], v[16:19], v[188:191]
    ds_read_b128 v[128:131], v6 offset:4096
    s_waitcnt lgkmcnt(7)
    v_mfma_f32_16x16x32_bf16 v[108:111], v[132:135], v[16:19], v[108:111]
    ds_read_b128 v[132:135], v6 offset:16384
    s_waitcnt lgkmcnt(7)
    v_mfma_f32_16x16x32_bf16 v[112:115], v[136:139], v[16:19], v[112:115]
    ds_read_b128 v[136:139], v6 offset:28672
    s_waitcnt lgkmcnt(7)
    v_mfma_f32_16x16x32_bf16 v[116:119], v[140:143], v[16:19], v[116:119]
    ds_read_b128 v[140:143], v7 offset:4096
    s_waitcnt lgkmcnt(7)
    s_waitcnt vmcnt(8)
    v_mfma_f32_16x16x32_bf16 v[104:107], v[144:147], v[20:23], v[104:107]
    v_mfma_f32_16x16x32_bf16 v[184:187], v[192:195], v[20:23], v[184:187]
    v_mfma_f32_16x16x32_bf16 v[188:191], v[20:23], v[20:23], v[188:191]
    ds_read_b128 v[144:147], v6 offset:5120
    s_waitcnt lgkmcnt(7)
    v_mfma_f32_16x16x32_bf16 v[108:111], v[148:151], v[20:23], v[108:111]
    ds_read_b128 v[148:151], v6 offset:17408
    s_waitcnt lgkmcnt(7)
    v_mfma_f32_16x16x32_bf16 v[112:115], v[152:155], v[20:23], v[112:115]
    ds_read_b128 v[152:155], v6 offset:29696
    s_waitcnt lgkmcnt(7)
    v_mfma_f32_16x16x32_bf16 v[116:119], v[156:159], v[20:23], v[116:119]
    ds_read_b128 v[156:159], v7 offset:5120
    s_waitcnt lgkmcnt(7)
    s_waitcnt vmcnt(7)
    v_mfma_f32_16x16x32_bf16 v[104:107], v[128:131], v[24:27], v[104:107]
    v_mfma_f32_16x16x32_bf16 v[184:187], v[192:195], v[24:27], v[184:187]
    v_mfma_f32_16x16x32_bf16 v[188:191], v[24:27], v[24:27], v[188:191]
    ds_read_b128 v[128:131], v6 offset:6144
    s_waitcnt lgkmcnt(7)
    v_mfma_f32_16x16x32_bf16 v[108:111], v[132:135], v[24:27], v[108:111]
    ds_read_b128 v[132:135], v6 offset:18432
    s_waitcnt lgkmcnt(7)
    v_mfma_f32_16x16x32_bf16 v[112:115], v[136:139], v[24:27], v[112:115]
    ds_read_b128 v[136:139], v6 offset:30720
    s_waitcnt lgkmcnt(7)
    v_mfma_f32_16x16x32_bf16 v[116:119], v[140:143], v[24:27], v[116:119]
    ds_read_b128 v[140:143], v7 offset:6144
    s_waitcnt lgkmcnt(7)
    s_waitcnt vmcnt(6)
    v_mfma_f32_16x16x32_bf16 v[104:107], v[144:147], v[28:31], v[104:107]
    v_mfma_f32_16x16x32_bf16 v[184:187], v[192:195], v[28:31], v[184:187]
    v_mfma_f32_16x16x32_bf16 v[188:191], v[28:31], v[28:31], v[188:191]
    ds_read_b128 v[144:147], v6 offset:7168
    s_waitcnt lgkmcnt(7)
    v_mfma_f32_16x16x32_bf16 v[108:111], v[148:151], v[28:31], v[108:111]
    ds_read_b128 v[148:151], v6 offset:19456
    s_waitcnt lgkmcnt(7)
    v_mfma_f32_16x16x32_bf16 v[112:115], v[152:155], v[28:31], v[112:115]
    ds_read_b128 v[152:155], v6 offset:31744
    s_waitcnt lgkmcnt(7)
    v_mfma_f32_16x16x32_bf16 v[116:119], v[156:159], v[28:31], v[116:119]
    ds_read_b128 v[156:159], v7 offset:7168
    s_waitcnt lgkmcnt(7)
    s_waitcnt vmcnt(5)
    v_mfma_f32_16x16x32_bf16 v[104:107], v[128:131], v[32:35], v[104:107]
    v_mfma_f32_16x16x32_bf16 v[184:187], v[192:195], v[32:35], v[184:187]
    v_mfma_f32_16x16x32_bf16 v[188:191], v[32:35], v[32:35], v[188:191]
    ds_read_b128 v[128:131], v6 offset:8192
    s_waitcnt lgkmcnt(7)
    v_mfma_f32_16x16x32_bf16 v[108:111], v[132:135], v[32:35], v[108:111]
    ds_read_b128 v[132:135], v6 offset:20480
    s_waitcnt lgkmcnt(7)
    v_mfma_f32_16x16x32_bf16 v[112:115], v[136:139], v[32:35], v[112:115]
    ds_read_b128 v[136:139], v6 offset:32768
    s_waitcnt lgkmcnt(7)
    v_mfma_f32_16x16x32_bf16 v[116:119], v[140:143], v[32:35], v[116:119]
    ds_read_b128 v[140:143], v7 offset:8192
    s_waitcnt lgkmcnt(7)
    s_waitcnt vmcnt(4)
    v_mfma_f32_16x16x32_bf16 v[104:107], v[144:147], v[36:39], v[104:107]
    v_mfma_f32_16x16x32_bf16 v[184:187], v[192:195], v[36:39], v[184:187]
    v_mfma_f32_16x16x32_bf16 v[188:191], v[36:39], v[36:39], v[188:191]
    ds_read_b128 v[144:147], v6 offset:9216
    s_waitcnt lgkmcnt(7)
    v_mfma_f32_16x16x32_bf16 v[108:111], v[148:151], v[36:39], v[108:111]
    ds_read_b128 v[148:151], v6 offset:21504
    s_waitcnt lgkmcnt(7)
    v_mfma_f32_16x16x32_bf16 v[112:115], v[152:155], v[36:39], v[112:115]
    ds_read_b128 v[152:155], v6 offset:33792
    s_waitcnt lgkmcnt(7)
    v_mfma_f32_16x16x32_bf16 v[116:119], v[156:159], v[36:39], v[116:119]
    ds_read_b128 v[156:159], v7 offset:9216
    s_waitcnt lgkmcnt(7)
    s_waitcnt vmcnt(3)
    v_mfma_f32_16x16x32_bf16 v[104:107], v[128:131], v[40:43], v[104:107]
    v_mfma_f32_16x16x32_bf16 v[184:187], v[192:195], v[40:43], v[184:187]
    v_mfma_f32_16x16x32_bf16 v[188:191], v[40:43], v[40:43], v[188:191]
    ds_read_b128 v[128:131], v6 offset:10240
    s_waitcnt lgkmcnt(7)
    v_mfma_f32_16x16x32_bf16 v[108:111], v[132:135], v[40:43], v[108:111]
    ds_read_b128 v[132:135], v6 offset:22528
    s_waitcnt lgkmcnt(7)
    v_mfma_f32_16x16x32_bf16 v[112:115], v[136:139], v[40:43], v[112:115]
    ds_read_b128 v[136:139], v6 offset:34816
    s_waitcnt lgkmcnt(7)
    v_mfma_f32_16x16x32_bf16 v[116:119], v[140:143], v[40:43], v[116:119]
    ds_read_b128 v[140:143], v7 offset:10240
    s_waitcnt lgkmcnt(7)
    s_waitcnt vmcnt(2)
    v_mfma_f32_16x16x32_bf16 v[104:107], v[144:147], v[44:47], v[104:107]
    v_mfma_f32_16x16x32_bf16 v[184:187], v[192:195], v[44:47], v[184:187]
    v_mfma_f32_16x16x32_bf16 v[188:191], v[44:47], v[44:47], v[188:191]
    ds_read_b128 v[144:147], v6 offset:11264
    s_waitcnt lgkmcnt(7)
    v_mfma_f32_16x16x32_bf16 v[108:111], v[148:151], v[44:47], v[108:111]
    ds_read_b128 v[148:151], v6 offset:23552
    s_waitcnt lgkmcnt(7)
    v_mfma_f32_16x16x32_bf16 v[112:115], v[152:155], v[44:47], v[112:115]
    ds_read_b128 v[152:155], v6 offset:35840
    s_waitcnt lgkmcnt(7)
    v_mfma_f32_16x16x32_bf16 v[116:119], v[156:159], v[44:47], v[116:119]
    ds_read_b128 v[156:159], v7 offset:11264
    s_waitcnt lgkmcnt(7)
    s_waitcnt vmcnt(1)
    v_mfma_f32_16x16x32_bf16 v[104:107], v[128:131], v[48:51], v[104:107]
    v_mfma_f32_16x16x32_bf16 v[184:187], v[192:195], v[48:51], v[184:187]
    v_mfma_f32_16x16x32_bf16 v[188:191], v[48:51], v[48:51], v[188:191]
    s_add_u32 s6, s57, 0
    s_add_u32 s7, s38, 98304
    s_mov_b32 m0, s7
    s_add_u32 s7, s7, 1024
    buffer_load_dwordx4 v168, s[8:11], s6 offen sc1 lds
    s_mov_b32 m0, s7
    s_add_u32 s7, s7, 1024
    buffer_load_dwordx4 v169, s[8:11], s6 offen sc1 lds
    s_mov_b32 m0, s7
    s_add_u32 s7, s7, 1024
    buffer_load_dwordx4 v170, s[8:11], s6 offen sc1 lds
    ds_read_b128 v[128:131], v7 offset:12288
    s_waitcnt lgkmcnt(7)
    v_mfma_f32_16x16x32_bf16 v[108:111], v[132:135], v[48:51], v[108:111]
    ds_read_b128 v[132:135], v7 offset:24576
    s_waitcnt lgkmcnt(7)
    v_mfma_f32_16x16x32_bf16 v[112:115], v[136:139], v[48:51], v[112:115]
    ds_read_b128 v[136:139], v7 offset:13312
    s_waitcnt lgkmcnt(7)
    v_mfma_f32_16x16x32_bf16 v[116:119], v[140:143], v[48:51], v[116:119]
    ds_read_b128 v[140:143], v7 offset:25600
    s_waitcnt lgkmcnt(7)
    s_waitcnt vmcnt(3)
    v_mfma_f32_16x16x32_bf16 v[104:107], v[144:147], v[52:55], v[104:107]
    v_mfma_f32_16x16x32_bf16 v[184:187], v[192:195], v[52:55], v[184:187]
    v_mfma_f32_16x16x32_bf16 v[188:191], v[52:55], v[52:55], v[188:191]
    ds_read_b128 v[144:147], v7 offset:14336
    s_waitcnt lgkmcnt(7)
    v_mfma_f32_16x16x32_bf16 v[108:111], v[148:151], v[52:55], v[108:111]
    ds_read_b128 v[148:151], v7 offset:26624
    s_waitcnt lgkmcnt(7)
    v_mfma_f32_16x16x32_bf16 v[112:115], v[152:155], v[52:55], v[112:115]
    s_add_u32 s6, s57, 4096
    s_add_u32 s7, s38, 122880
    s_mov_b32 m0, s7
    s_add_u32 s7, s7, 1024
    buffer_load_dwordx4 v168, s[8:11], s6 offen sc1 lds
    s_mov_b32 m0, s7
    s_add_u32 s7, s7, 1024
    buffer_load_dwordx4 v169, s[8:11], s6 offen sc1 lds
    s_mov_b32 m0, s7
    s_add_u32 s7, s7, 1024
    buffer_load_dwordx4 v170, s[8:11], s6 offen sc1 lds
    ds_read_b128 v[152:155], v7 offset:15360
    s_waitcnt lgkmcnt(7)
    v_mfma_f32_16x16x32_bf16 v[116:119], v[156:159], v[52:55], v[116:119]
    ds_read_b128 v[156:159], v7 offset:27648
    s_waitcnt lgkmcnt(7)
    v_mfma_f32_16x16x32_bf16 v[120:123], v[128:131], v[8:11], 0
    v_and_b32 v162, 1, v2
    v_cmp_eq_u32 vcc, 0, v162
    v_and_b32 v162, 2, v2
    v_lshrrev_b32 v163, 2, v2
    v_cndmask_b32 v188, v189, v188, vcc
    v_cndmask_b32 v190, v191, v190, vcc
    v_cmp_eq_u32 vcc, 0, v162
    v_mul_f32 v160, 0x3b2aaaab, v184
    s_nop 0
    v_cndmask_b32 v188, v190, v188, vcc
    v_cmp_eq_u32 vcc, v3, v163
    s_nop 1
    v_cndmask_b32 v161, 0, v188, vcc
    v_mov_b32 v162, v161
    s_nop 1
    v_permlane32_swap_b32 v161, v162
    s_nop 1
    v_add_f32 v161, v161, v162
    v_mov_b32 v162, v161
    s_nop 1
    v_permlane16_swap_b32 v161, v162
    s_nop 1
    v_add_f32 v161, v161, v162
    v_mul_f32 v161, 0x3b2aaaab, v161
    v_fma_f32 v161, -v160, v160, v161
    v_max_f32 v161, 0, v161
    v_add_f32 v161, 0x3727c5ac, v161
    v_rsq_f32 v161, v161
    s_nop 0
    ds_read_b128 v[128:131], v7 offset:16384
    s_waitcnt lgkmcnt(7)
    v_mfma_f32_16x16x32_bf16 v[124:127], v[132:135], v[8:11], 0
    v_fma_f32 v104, -v160, v200, v104
    v_fma_f32 v105, -v160, v201, v105
    v_fma_f32 v106, -v160, v202, v106
    v_fma_f32 v107, -v160, v203, v107
    ds_read_b128 v[132:135], v7 offset:28672
    s_waitcnt lgkmcnt(7)
    v_mfma_f32_16x16x32_bf16 v[120:123], v[136:139], v[12:15], v[120:123]
    v_fma_f32 v108, -v160, v204, v108
    v_fma_f32 v109, -v160, v205, v109
    v_fma_f32 v110, -v160, v206, v110
    v_fma_f32 v111, -v160, v207, v111
    ds_read_b128 v[136:139], v7 offset:17408
    s_waitcnt lgkmcnt(7)
    v_mfma_f32_16x16x32_bf16 v[124:127], v[140:143], v[12:15], v[124:127]
    v_fma_f32 v104, v104, v161, v224
    v_fma_f32 v105, v105, v161, v225
    v_fma_f32 v106, v106, v161, v226
    v_fma_f32 v107, v107, v161, v227
    ds_read_b128 v[140:143], v7 offset:29696
    s_waitcnt lgkmcnt(7)
    v_mfma_f32_16x16x32_bf16 v[120:123], v[144:147], v[16:19], v[120:123]
    v_fma_f32 v108, v108, v161, v228
    v_fma_f32 v109, v109, v161, v229
    v_fma_f32 v110, v110, v161, v230
    v_fma_f32 v111, v111, v161, v231
    ds_read_b128 v[144:147], v7 offset:18432
    s_waitcnt lgkmcnt(7)
    v_mfma_f32_16x16x32_bf16 v[124:127], v[148:151], v[16:19], v[124:127]
    v_mul_f32 v64, v104, v104
    v_mul_f32 v65, v105, v105
    v_mul_f32 v66, v106, v106
    v_mul_f32 v67, v107, v107
    ds_read_b128 v[148:151], v7 offset:30720
    s_waitcnt lgkmcnt(7)
    v_mfma_f32_16x16x32_bf16 v[120:123], v[152:155], v[20:23], v[120:123]
    s_cmp_ge_u32 s3, 4
    s_cbranch_scc1 L_standalone__dit_block__diffusion_kernel_f2_16
    s_add_u32 s6, s57, 8192
    s_add_u32 s7, s38, 147456
    s_mov_b32 m0, s7
    s_add_u32 s7, s7, 1024
    buffer_load_dwordx4 v168, s[8:11], s6 offen sc1 lds
    s_mov_b32 m0, s7
    s_add_u32 s7, s7, 1024
    buffer_load_dwordx4 v169, s[8:11], s6 offen sc1 lds
    s_mov_b32 m0, s7
    s_add_u32 s7, s7, 1024
    buffer_load_dwordx4 v170, s[8:11], s6 offen sc1 lds
L_standalone__dit_block__diffusion_kernel_f2_16:
    v_mul_f32 v68, v108, v108
    v_mul_f32 v69, v109, v109
    v_mul_f32 v70, v110, v110
    v_mul_f32 v71, v111, v111
    ds_read_b128 v[152:155], v7 offset:19456
    s_waitcnt lgkmcnt(7)
    v_mfma_f32_16x16x32_bf16 v[124:127], v[156:159], v[20:23], v[124:127]
    v_fma_f32 v64, v64, v84, v85
    v_fma_f32 v65, v65, v84, v85
    v_fma_f32 v66, v66, v84, v85
    v_fma_f32 v67, v67, v84, v85
    ds_read_b128 v[156:159], v7 offset:31744
    s_waitcnt lgkmcnt(7)
    v_mfma_f32_16x16x32_bf16 v[120:123], v[128:131], v[24:27], v[120:123]
    v_fma_f32 v68, v68, v84, v85
    v_fma_f32 v69, v69, v84, v85
    v_fma_f32 v70, v70, v84, v85
    v_fma_f32 v71, v71, v84, v85
    ds_read_b128 v[128:131], v7 offset:20480
    s_waitcnt lgkmcnt(7)
    v_mfma_f32_16x16x32_bf16 v[124:127], v[132:135], v[24:27], v[124:127]
    v_mul_f32 v64, v64, v104
    v_mul_f32 v65, v65, v105
    v_mul_f32 v66, v66, v106
    v_mul_f32 v67, v67, v107
    ds_read_b128 v[132:135], v7 offset:32768
    s_waitcnt lgkmcnt(7)
    v_mfma_f32_16x16x32_bf16 v[120:123], v[136:139], v[28:31], v[120:123]
    v_mul_f32 v68, v68, v108
    v_mul_f32 v69, v69, v109
    v_mul_f32 v70, v70, v110
    v_mul_f32 v71, v71, v111
    ds_read_b128 v[136:139], v7 offset:21504
    s_waitcnt lgkmcnt(7)
    v_mfma_f32_16x16x32_bf16 v[124:127], v[140:143], v[28:31], v[124:127]
    v_exp_f32 v64, v64
    v_exp_f32 v65, v65
    v_exp_f32 v66, v66
    v_exp_f32 v67, v67
    ds_read_b128 v[140:143], v7 offset:33792
    s_waitcnt lgkmcnt(7)
    v_mfma_f32_16x16x32_bf16 v[120:123], v[144:147], v[32:35], v[120:123]
    v_exp_f32 v68, v68
    v_exp_f32 v69, v69
    v_exp_f32 v70, v70
    v_exp_f32 v71, v71
    ds_read_b128 v[144:147], v7 offset:22528
    s_waitcnt lgkmcnt(7)
    v_mfma_f32_16x16x32_bf16 v[124:127], v[148:151], v[32:35], v[124:127]
    v_add_f32 v64, v64, v86
    v_add_f32 v65, v65, v86
    v_add_f32 v66, v66, v86
    v_add_f32 v67, v67, v86
    ds_read_b128 v[148:151], v7 offset:34816
    s_waitcnt lgkmcnt(7)
    v_mfma_f32_16x16x32_bf16 v[120:123], v[152:155], v[36:39], v[120:123]
    s_add_u32 s6, s57, 10240
    s_add_u32 s7, s38, 0
    s_mov_b32 m0, s7
    s_add_u32 s7, s7, 1024
    buffer_load_dwordx4 v168, s[8:11], s6 offen sc1 lds
    s_mov_b32 m0, s7
    s_add_u32 s7, s7, 1024
    buffer_load_dwordx4 v169, s[8:11], s6 offen sc1 lds
    s_mov_b32 m0, s7
    s_add_u32 s7, s7, 1024
    buffer_load_dwordx4 v170, s[8:11], s6 offen sc1 lds
    v_add_f32 v68, v68, v86
    v_add_f32 v69, v69, v86
    v_add_f32 v70, v70, v86
    v_add_f32 v71, v71, v86
    ds_read_b128 v[152:155], v7 offset:23552
    s_waitcnt lgkmcnt(7)
    v_mfma_f32_16x16x32_bf16 v[124:127], v[156:159], v[36:39], v[124:127]
    v_rcp_f32 v64, v64
    v_rcp_f32 v65, v65
    v_rcp_f32 v66, v66
    v_rcp_f32 v67, v67
    ds_read_b128 v[156:159], v7 offset:35840
    s_waitcnt lgkmcnt(7)
    v_mfma_f32_16x16x32_bf16 v[120:123], v[128:131], v[40:43], v[120:123]
    v_rcp_f32 v68, v68
    v_rcp_f32 v69, v69
    v_rcp_f32 v70, v70
    v_rcp_f32 v71, v71
    s_waitcnt lgkmcnt(6)
    v_mfma_f32_16x16x32_bf16 v[124:127], v[132:135], v[40:43], v[124:127]
    v_mul_f32 v104, v104, v64
    v_mul_f32 v105, v105, v65
    v_mul_f32 v106, v106, v66
    v_mul_f32 v107, v107, v67
    s_waitcnt lgkmcnt(5)
    v_mfma_f32_16x16x32_bf16 v[120:123], v[136:139], v[44:47], v[120:123]
    v_mul_f32 v108, v108, v68
    v_mul_f32 v109, v109, v69
    v_mul_f32 v110, v110, v70
    v_mul_f32 v111, v111, v71
    s_waitcnt lgkmcnt(4)
    v_mfma_f32_16x16x32_bf16 v[124:127], v[140:143], v[44:47], v[124:127]
    v_cvt_pk_bf16_f32 v72, v104, v105
    v_cvt_pk_bf16_f32 v73, v106, v107
    v_cvt_pk_bf16_f32 v74, v108, v109
    v_cvt_pk_bf16_f32 v75, v110, v111
    s_waitcnt lgkmcnt(3)
    v_mfma_f32_16x16x32_bf16 v[120:123], v[144:147], v[48:51], v[120:123]
    buffer_store_dwordx4 v[72:75], v4, s[8:11], s32 offen offset:0 sc1
    s_waitcnt lgkmcnt(2)
    v_mfma_f32_16x16x32_bf16 v[124:127], v[148:151], v[48:51], v[124:127]
    s_waitcnt lgkmcnt(1)
    v_mfma_f32_16x16x32_bf16 v[120:123], v[152:155], v[52:55], v[120:123]
    s_waitcnt lgkmcnt(0)
    v_mfma_f32_16x16x32_bf16 v[124:127], v[156:159], v[52:55], v[124:127]
    v_pk_fma_f32 v[112:113], v[160:161], v[208:209], v[112:113] op_sel:[0,0,0] op_sel_hi:[0,1,1] neg_lo:[1,0,0] neg_hi:[1,0,0]
    v_pk_fma_f32 v[114:115], v[160:161], v[210:211], v[114:115] op_sel:[0,0,0] op_sel_hi:[0,1,1] neg_lo:[1,0,0] neg_hi:[1,0,0]
    v_pk_fma_f32 v[116:117], v[160:161], v[212:213], v[116:117] op_sel:[0,0,0] op_sel_hi:[0,1,1] neg_lo:[1,0,0] neg_hi:[1,0,0]
    v_pk_fma_f32 v[118:119], v[160:161], v[214:215], v[118:119] op_sel:[0,0,0] op_sel_hi:[0,1,1] neg_lo:[1,0,0] neg_hi:[1,0,0]
    v_pk_fma_f32 v[112:113], v[112:113], v[160:161], v[232:233] op_sel:[0,1,0] op_sel_hi:[1,1,1]
    v_pk_fma_f32 v[114:115], v[114:115], v[160:161], v[234:235] op_sel:[0,1,0] op_sel_hi:[1,1,1]
    v_pk_fma_f32 v[116:117], v[116:117], v[160:161], v[236:237] op_sel:[0,1,0] op_sel_hi:[1,1,1]
    v_pk_fma_f32 v[118:119], v[118:119], v[160:161], v[238:239] op_sel:[0,1,0] op_sel_hi:[1,1,1]
    v_pk_mul_f32 v[64:65], v[112:113], v[112:113] op_sel:[0,0] op_sel_hi:[1,1]
    v_pk_mul_f32 v[66:67], v[114:115], v[114:115] op_sel:[0,0] op_sel_hi:[1,1]
    v_pk_mul_f32 v[68:69], v[116:117], v[116:117] op_sel:[0,0] op_sel_hi:[1,1]
    v_pk_mul_f32 v[70:71], v[118:119], v[118:119] op_sel:[0,0] op_sel_hi:[1,1]
    v_pk_fma_f32 v[64:65], v[64:65], v[84:85], v[84:85] op_sel:[0,0,1] op_sel_hi:[1,0,1]
    v_pk_fma_f32 v[66:67], v[66:67], v[84:85], v[84:85] op_sel:[0,0,1] op_sel_hi:[1,0,1]
    v_pk_fma_f32 v[68:69], v[68:69], v[84:85], v[84:85] op_sel:[0,0,1] op_sel_hi:[1,0,1]
    v_pk_fma_f32 v[70:71], v[70:71], v[84:85], v[84:85] op_sel:[0,0,1] op_sel_hi:[1,0,1]
    v_pk_mul_f32 v[64:65], v[64:65], v[112:113] op_sel:[0,0] op_sel_hi:[1,1]
    v_pk_mul_f32 v[66:67], v[66:67], v[114:115] op_sel:[0,0] op_sel_hi:[1,1]
    v_pk_mul_f32 v[68:69], v[68:69], v[116:117] op_sel:[0,0] op_sel_hi:[1,1]
    v_pk_mul_f32 v[70:71], v[70:71], v[118:119] op_sel:[0,0] op_sel_hi:[1,1]
    v_exp_f32 v64, v64
    v_exp_f32 v65, v65
    v_exp_f32 v66, v66
    v_exp_f32 v67, v67
    v_exp_f32 v68, v68
    v_exp_f32 v69, v69
    v_exp_f32 v70, v70
    v_exp_f32 v71, v71
    v_pk_add_f32 v[64:65], v[64:65], v[86:87] op_sel:[0,0] op_sel_hi:[1,0]
    v_pk_add_f32 v[66:67], v[66:67], v[86:87] op_sel:[0,0] op_sel_hi:[1,0]
    v_pk_add_f32 v[68:69], v[68:69], v[86:87] op_sel:[0,0] op_sel_hi:[1,0]
    v_pk_add_f32 v[70:71], v[70:71], v[86:87] op_sel:[0,0] op_sel_hi:[1,0]
    v_rcp_f32 v64, v64
    v_rcp_f32 v65, v65
    v_rcp_f32 v66, v66
    v_rcp_f32 v67, v67
    v_rcp_f32 v68, v68
    v_rcp_f32 v69, v69
    v_rcp_f32 v70, v70
    v_rcp_f32 v71, v71
    v_pk_mul_f32 v[112:113], v[112:113], v[64:65] op_sel:[0,0] op_sel_hi:[1,1]
    v_pk_mul_f32 v[114:115], v[114:115], v[66:67] op_sel:[0,0] op_sel_hi:[1,1]
    v_pk_mul_f32 v[116:117], v[116:117], v[68:69] op_sel:[0,0] op_sel_hi:[1,1]
    v_pk_mul_f32 v[118:119], v[118:119], v[70:71] op_sel:[0,0] op_sel_hi:[1,1]
    v_cvt_pk_bf16_f32 v76, v112, v113
    v_cvt_pk_bf16_f32 v77, v114, v115
    v_cvt_pk_bf16_f32 v78, v116, v117
    v_cvt_pk_bf16_f32 v79, v118, v119
    buffer_store_dwordx4 v[76:79], v4, s[8:11], s32 offen offset:1024 sc1
    v_pk_fma_f32 v[120:121], v[160:161], v[216:217], v[120:121] op_sel:[0,0,0] op_sel_hi:[0,1,1] neg_lo:[1,0,0] neg_hi:[1,0,0]
    v_pk_fma_f32 v[122:123], v[160:161], v[218:219], v[122:123] op_sel:[0,0,0] op_sel_hi:[0,1,1] neg_lo:[1,0,0] neg_hi:[1,0,0]
    v_pk_fma_f32 v[124:125], v[160:161], v[220:221], v[124:125] op_sel:[0,0,0] op_sel_hi:[0,1,1] neg_lo:[1,0,0] neg_hi:[1,0,0]
    v_pk_fma_f32 v[126:127], v[160:161], v[222:223], v[126:127] op_sel:[0,0,0] op_sel_hi:[0,1,1] neg_lo:[1,0,0] neg_hi:[1,0,0]
    v_pk_fma_f32 v[120:121], v[120:121], v[160:161], v[240:241] op_sel:[0,1,0] op_sel_hi:[1,1,1]
    v_pk_fma_f32 v[122:123], v[122:123], v[160:161], v[242:243] op_sel:[0,1,0] op_sel_hi:[1,1,1]
    v_pk_fma_f32 v[124:125], v[124:125], v[160:161], v[244:245] op_sel:[0,1,0] op_sel_hi:[1,1,1]
    v_pk_fma_f32 v[126:127], v[126:127], v[160:161], v[246:247] op_sel:[0,1,0] op_sel_hi:[1,1,1]
    v_pk_mul_f32 v[64:65], v[120:121], v[120:121] op_sel:[0,0] op_sel_hi:[1,1]
    v_pk_mul_f32 v[66:67], v[122:123], v[122:123] op_sel:[0,0] op_sel_hi:[1,1]
    v_pk_mul_f32 v[68:69], v[124:125], v[124:125] op_sel:[0,0] op_sel_hi:[1,1]
    v_pk_mul_f32 v[70:71], v[126:127], v[126:127] op_sel:[0,0] op_sel_hi:[1,1]
    v_pk_fma_f32 v[64:65], v[64:65], v[84:85], v[84:85] op_sel:[0,0,1] op_sel_hi:[1,0,1]
    v_pk_fma_f32 v[66:67], v[66:67], v[84:85], v[84:85] op_sel:[0,0,1] op_sel_hi:[1,0,1]
    v_pk_fma_f32 v[68:69], v[68:69], v[84:85], v[84:85] op_sel:[0,0,1] op_sel_hi:[1,0,1]
    v_pk_fma_f32 v[70:71], v[70:71], v[84:85], v[84:85] op_sel:[0,0,1] op_sel_hi:[1,0,1]
    v_pk_mul_f32 v[64:65], v[64:65], v[120:121] op_sel:[0,0] op_sel_hi:[1,1]
    v_pk_mul_f32 v[66:67], v[66:67], v[122:123] op_sel:[0,0] op_sel_hi:[1,1]
    v_pk_mul_f32 v[68:69], v[68:69], v[124:125] op_sel:[0,0] op_sel_hi:[1,1]
    v_pk_mul_f32 v[70:71], v[70:71], v[126:127] op_sel:[0,0] op_sel_hi:[1,1]
    v_exp_f32 v64, v64
    v_exp_f32 v65, v65
    v_exp_f32 v66, v66
    v_exp_f32 v67, v67
    v_exp_f32 v68, v68
    v_exp_f32 v69, v69
    v_exp_f32 v70, v70
    v_exp_f32 v71, v71
    v_pk_add_f32 v[64:65], v[64:65], v[86:87] op_sel:[0,0] op_sel_hi:[1,0]
    v_pk_add_f32 v[66:67], v[66:67], v[86:87] op_sel:[0,0] op_sel_hi:[1,0]
    v_pk_add_f32 v[68:69], v[68:69], v[86:87] op_sel:[0,0] op_sel_hi:[1,0]
    v_pk_add_f32 v[70:71], v[70:71], v[86:87] op_sel:[0,0] op_sel_hi:[1,0]
    v_rcp_f32 v64, v64
    v_rcp_f32 v65, v65
    v_rcp_f32 v66, v66
    v_rcp_f32 v67, v67
    v_rcp_f32 v68, v68
    v_rcp_f32 v69, v69
    v_rcp_f32 v70, v70
    v_rcp_f32 v71, v71
    v_pk_mul_f32 v[120:121], v[120:121], v[64:65] op_sel:[0,0] op_sel_hi:[1,1]
    v_pk_mul_f32 v[122:123], v[122:123], v[66:67] op_sel:[0,0] op_sel_hi:[1,1]
    v_pk_mul_f32 v[124:125], v[124:125], v[68:69] op_sel:[0,0] op_sel_hi:[1,1]
    v_pk_mul_f32 v[126:127], v[126:127], v[70:71] op_sel:[0,0] op_sel_hi:[1,1]
    v_cvt_pk_bf16_f32 v80, v120, v121
    v_cvt_pk_bf16_f32 v81, v122, v123
    v_cvt_pk_bf16_f32 v82, v124, v125
    v_cvt_pk_bf16_f32 v83, v126, v127
    buffer_store_dwordx4 v[80:83], v4, s[8:11], s32 offen offset:2048 sc1
    s_waitcnt vmcnt(0)
    s_barrier
    s_cmp_lg_u32 s3, 0
    s_cbranch_scc1 L_standalone__dit_block__diffusion_kernel_sg4
    v_mov_b32 v5, 0
    v_mov_b32 v6, 1
    s_lshl_b32 s35, s35, 5
    s_add_u32 s35, s35, 0x40000
    s_mov_b64 exec, 1
    buffer_store_dword v6, v5, s[8:11], s35 offen sc1
    s_mov_b64 exec, -1
L_standalone__dit_block__diffusion_kernel_sg4:
    s_add_u32 s6, s57, 14336
    s_add_u32 s7, s38, 24576
    s_mov_b32 m0, s7
    s_add_u32 s7, s7, 1024
    buffer_load_dwordx4 v168, s[8:11], s6 offen sc1 lds
    s_mov_b32 m0, s7
    s_add_u32 s7, s7, 1024
    buffer_load_dwordx4 v169, s[8:11], s6 offen sc1 lds
    s_mov_b32 m0, s7
    s_add_u32 s7, s7, 1024
    buffer_load_dwordx4 v170, s[8:11], s6 offen sc1 lds
    s_add_u32 s6, s57, 18432
    s_add_u32 s7, s38, 49152
    s_mov_b32 m0, s7
    s_add_u32 s7, s7, 1024
    buffer_load_dwordx4 v168, s[8:11], s6 offen sc1 lds
    s_mov_b32 m0, s7
    s_add_u32 s7, s7, 1024
    buffer_load_dwordx4 v169, s[8:11], s6 offen sc1 lds
    s_mov_b32 m0, s7
    s_add_u32 s7, s7, 1024
    buffer_load_dwordx4 v170, s[8:11], s6 offen sc1 lds
    s_cmp_ge_u32 s3, 4
    s_cbranch_scc1 L_standalone__dit_block__diffusion_kernel_f2_44
    s_add_u32 s6, s57, 22528
    s_add_u32 s7, s38, 73728
    s_mov_b32 m0, s7
    s_add_u32 s7, s7, 1024
    buffer_load_dwordx4 v168, s[8:11], s6 offen sc1 lds
    s_mov_b32 m0, s7
    s_add_u32 s7, s7, 1024
    buffer_load_dwordx4 v169, s[8:11], s6 offen sc1 lds
    s_mov_b32 m0, s7
    s_add_u32 s7, s7, 1024
    buffer_load_dwordx4 v170, s[8:11], s6 offen sc1 lds
L_standalone__dit_block__diffusion_kernel_f2_44:
    s_lshr_b32 s23, s3, 2
    s_mul_i32 s25, s56, 49152
    s_mul_i32 s6, s23, 24576
    s_add_u32 s25, s25, s6
    s_add_u32 s25, s25, 0x1300000
    s_mul_i32 s29, s56, 12288
    s_mul_i32 s6, s55, 1536
    s_add_u32 s29, s29, s6
    s_add_u32 s29, s29, 0x1100000
    s_lshr_b32 s6, s54, 4
    s_mul_i32 s30, s6, 9216
    s_mul_i32 s6, s55, 192
    s_add_u32 s30, s30, s6
    s_add_u32 s30, s30, 7680
    s_cmp_lg_u32 s3, 7
    s_cbranch_scc1 L_standalone__dit_block__diffusion_kernel_pd5
    s_lshr_b32 s6, s54, 1
    s_lshl_b32 s6, s6, 6
    s_add_u32 s6, s6, 5120
    v_lshlrev_b32 v5, 2, v2
    v_add_u32 v5, s6, v5
    v_lshlrev_b32 v5, 5, v5
    s_mov_b32 s6, 0x40000
    s_mov_b32 s7, 0
L_standalone__dit_block__diffusion_kernel_pl5:
    buffer_load_dword v6, v5, s[8:11], s6 offen sc1
    s_waitcnt vmcnt(0)
    v_cmp_eq_u32 vcc, 0, v6
    s_add_u32 s7, s7, 1
    s_cmp_ge_u32 s7, 0x10000
    s_cbranch_scc1 L_standalone__dit_block__diffusion_kernel_pd5
    s_nop 2
    s_cbranch_vccz L_standalone__dit_block__diffusion_kernel_pd5
    s_sleep 3
    s_branch L_standalone__dit_block__diffusion_kernel_pl5
L_standalone__dit_block__diffusion_kernel_pd5:
    s_barrier
    buffer_load_dwordx4 v[8:11], v4, s[8:11], s25 offen sc1
    buffer_load_dwordx4 v[12:15], v4, s[8:11], s25 offen offset:1024 sc1
    buffer_load_dwordx4 v[16:19], v4, s[8:11], s25 offen offset:2048 sc1
    buffer_load_dwordx4 v[20:23], v4, s[8:11], s25 offen offset:3072 sc1
    s_add_u32 s25, s25, 4096
    buffer_load_dwordx4 v[24:27], v4, s[8:11], s25 offen sc1
    buffer_load_dwordx4 v[28:31], v4, s[8:11], s25 offen offset:1024 sc1
    buffer_load_dwordx4 v[32:35], v4, s[8:11], s25 offen offset:2048 sc1
    buffer_load_dwordx4 v[36:39], v4, s[8:11], s25 offen offset:3072 sc1
    s_add_u32 s25, s25, 4096
    buffer_load_dwordx4 v[40:43], v4, s[8:11], s25 offen sc1
    buffer_load_dwordx4 v[44:47], v4, s[8:11], s25 offen offset:1024 sc1
    buffer_load_dwordx4 v[48:51], v4, s[8:11], s25 offen offset:2048 sc1
    buffer_load_dwordx4 v[52:55], v4, s[8:11], s25 offen offset:3072 sc1
    s_mul_i32 s6, s23, 3072
    v_add_u32 v5, s6, v4
    v_add_u32 v6, 61440, v5
    v_add_u32 v7, 61440, v6
    v_lshlrev_b32 v1, 4, v3
    v_lshrrev_b32 v160, 1, v3
    v_lshlrev_b32 v160, 8, v160
    v_lshl_add_u32 v160, v2, 4, v160
    v_and_b32 v161, 1, v3
    v_lshl_add_u32 v160, v161, 3, v160
    ds_read_b128 v[128:131], v6 offset:36864
    ds_read_b128 v[132:135], v6 offset:37888
    ds_read_b128 v[136:139], v6 offset:38912
    ds_read_b128 v[140:143], v6 offset:43008
    ds_read_b128 v[144:147], v6 offset:44032
    ds_read_b128 v[148:151], v6 offset:45056
    ds_read_b128 v[152:155], v6 offset:49152
    ds_read_b128 v[156:159], v6 offset:50176
    s_waitcnt lgkmcnt(7)
    s_waitcnt vmcnt(11)
    s_add_u32 s25, s25, 4096
    buffer_load_dwordx4 v[56:59], v4, s[8:11], s25 offen sc1
    v_mfma_f32_16x16x32_bf16 v[104:107], v[128:131], v[8:11], 0
    ds_read_b128 v[128:131], v6 offset:51200
    s_waitcnt lgkmcnt(7)
    v_mfma_f32_16x16x32_bf16 v[108:111], v[132:135], v[8:11], 0
    ds_read_b128 v[132:135], v6 offset:55296
    s_waitcnt lgkmcnt(7)
    v_mfma_f32_16x16x32_bf16 v[112:115], v[136:139], v[8:11], 0
    ds_read_b128 v[136:139], v6 offset:56320
    s_waitcnt lgkmcnt(7)
    s_waitcnt vmcnt(11)
    buffer_load_dwordx4 v[60:63], v4, s[8:11], s25 offen offset:1024 sc1
    v_mfma_f32_16x16x32_bf16 v[104:107], v[140:143], v[12:15], v[104:107]
    ds_read_b128 v[140:143], v6 offset:57344
    s_waitcnt lgkmcnt(7)
    v_mfma_f32_16x16x32_bf16 v[108:111], v[144:147], v[12:15], v[108:111]
    ds_read_b128 v[144:147], v7 offset:0
    s_waitcnt lgkmcnt(7)
    v_mfma_f32_16x16x32_bf16 v[112:115], v[148:151], v[12:15], v[112:115]
    ds_read_b128 v[148:151], v7 offset:1024
    s_waitcnt lgkmcnt(7)
    s_waitcnt vmcnt(11)
    buffer_load_dwordx4 v[64:67], v4, s[8:11], s25 offen offset:2048 sc1
    v_mfma_f32_16x16x32_bf16 v[104:107], v[152:155], v[16:19], v[104:107]
    ds_read_b128 v[152:155], v7 offset:2048
    s_waitcnt lgkmcnt(7)
    v_mfma_f32_16x16x32_bf16 v[108:111], v[156:159], v[16:19], v[108:111]
    ds_read_b128 v[156:159], v7 offset:6144
    s_waitcnt lgkmcnt(7)
    v_mfma_f32_16x16x32_bf16 v[112:115], v[128:131], v[16:19], v[112:115]
    ds_read_b128 v[128:131], v7 offset:7168
    s_waitcnt lgkmcnt(7)
    s_waitcnt vmcnt(11)
    buffer_load_dwordx4 v[68:71], v4, s[8:11], s25 offen offset:3072 sc1
    v_mfma_f32_16x16x32_bf16 v[104:107], v[132:135], v[20:23], v[104:107]
    ds_read_b128 v[132:135], v7 offset:8192
    s_waitcnt lgkmcnt(7)
    v_mfma_f32_16x16x32_bf16 v[108:111], v[136:139], v[20:23], v[108:111]
    ds_read_b128 v[136:139], v7 offset:12288
    s_waitcnt lgkmcnt(7)
    v_mfma_f32_16x16x32_bf16 v[112:115], v[140:143], v[20:23], v[112:115]
    ds_read_b128 v[140:143], v7 offset:13312
    s_waitcnt lgkmcnt(7)
    s_waitcnt vmcnt(11)
    s_add_u32 s25, s25, 4096
    buffer_load_dwordx4 v[72:75], v4, s[8:11], s25 offen sc1
    v_mfma_f32_16x16x32_bf16 v[104:107], v[144:147], v[24:27], v[104:107]
    ds_read_b128 v[144:147], v7 offset:14336
    s_waitcnt lgkmcnt(7)
    v_mfma_f32_16x16x32_bf16 v[108:111], v[148:151], v[24:27], v[108:111]
    ds_read_b128 v[148:151], v7 offset:18432
    s_waitcnt lgkmcnt(7)
    v_mfma_f32_16x16x32_bf16 v[112:115], v[152:155], v[24:27], v[112:115]
    ds_read_b128 v[152:155], v7 offset:19456
    s_waitcnt lgkmcnt(7)
    s_waitcnt vmcnt(11)
    buffer_load_dwordx4 v[76:79], v4, s[8:11], s25 offen offset:1024 sc1
    v_mfma_f32_16x16x32_bf16 v[104:107], v[156:159], v[28:31], v[104:107]
    ds_read_b128 v[156:159], v7 offset:20480
    s_waitcnt lgkmcnt(7)
    v_mfma_f32_16x16x32_bf16 v[108:111], v[128:131], v[28:31], v[108:111]
    ds_read_b128 v[128:131], v7 offset:24576
    s_waitcnt lgkmcnt(7)
    v_mfma_f32_16x16x32_bf16 v[112:115], v[132:135], v[28:31], v[112:115]
    ds_read_b128 v[132:135], v7 offset:25600
    s_waitcnt lgkmcnt(7)
    s_waitcnt vmcnt(11)
    buffer_load_dwordx4 v[80:83], v4, s[8:11], s25 offen offset:2048 sc1
    v_mfma_f32_16x16x32_bf16 v[104:107], v[136:139], v[32:35], v[104:107]
    ds_read_b128 v[136:139], v7 offset:26624
    s_waitcnt lgkmcnt(7)
    v_mfma_f32_16x16x32_bf16 v[108:111], v[140:143], v[32:35], v[108:111]
    ds_read_b128 v[140:143], v7 offset:30720
    s_waitcnt lgkmcnt(7)
    v_mfma_f32_16x16x32_bf16 v[112:115], v[144:147], v[32:35], v[112:115]
    ds_read_b128 v[144:147], v7 offset:31744
    s_waitcnt lgkmcnt(7)
    s_waitcnt vmcnt(11)
    buffer_load_dwordx4 v[84:87], v4, s[8:11], s25 offen offset:3072 sc1
    v_mfma_f32_16x16x32_bf16 v[104:107], v[148:151], v[36:39], v[104:107]
    ds_read_b128 v[148:151], v7 offset:32768
    s_waitcnt lgkmcnt(7)
    v_mfma_f32_16x16x32_bf16 v[108:111], v[152:155], v[36:39], v[108:111]
    ds_read_b128 v[152:155], v5 offset:0
    s_waitcnt lgkmcnt(7)
    v_mfma_f32_16x16x32_bf16 v[112:115], v[156:159], v[36:39], v[112:115]
    ds_read_b128 v[156:159], v5 offset:1024
    s_waitcnt lgkmcnt(7)
    s_waitcnt vmcnt(11)
    s_add_u32 s25, s25, 4096
    buffer_load_dwordx4 v[88:91], v4, s[8:11], s25 offen sc1
    s_barrier
    v_mfma_f32_16x16x32_bf16 v[104:107], v[128:131], v[40:43], v[104:107]
    ds_read_b128 v[128:131], v5 offset:2048
    s_waitcnt lgkmcnt(7)
    v_mfma_f32_16x16x32_bf16 v[108:111], v[132:135], v[40:43], v[108:111]
    ds_read_b128 v[132:135], v5 offset:6144
    s_waitcnt lgkmcnt(7)
    v_mfma_f32_16x16x32_bf16 v[112:115], v[136:139], v[40:43], v[112:115]
    ds_read_b128 v[136:139], v5 offset:7168
    s_waitcnt lgkmcnt(7)
    s_waitcnt vmcnt(11)
    buffer_load_dwordx4 v[92:95], v4, s[8:11], s25 offen offset:1024 sc1
    v_mfma_f32_16x16x32_bf16 v[104:107], v[140:143], v[44:47], v[104:107]
    ds_read_b128 v[140:143], v5 offset:8192
    s_waitcnt lgkmcnt(7)
    v_mfma_f32_16x16x32_bf16 v[108:111], v[144:147], v[44:47], v[108:111]
    ds_read_b128 v[144:147], v5 offset:12288
    s_waitcnt lgkmcnt(7)
    v_mfma_f32_16x16x32_bf16 v[112:115], v[148:151], v[44:47], v[112:115]
    ds_read_b128 v[148:151], v5 offset:13312
    s_waitcnt lgkmcnt(7)
    s_waitcnt vmcnt(11)
    buffer_load_dwordx4 v[96:99], v4, s[8:11], s25 offen offset:2048 sc1
    v_mfma_f32_16x16x32_bf16 v[104:107], v[152:155], v[48:51], v[104:107]
    ds_read_b128 v[152:155], v5 offset:14336
    s_waitcnt lgkmcnt(7)
    v_mfma_f32_16x16x32_bf16 v[108:111], v[156:159], v[48:51], v[108:111]
    ds_read_b128 v[156:159], v5 offset:18432
    s_waitcnt lgkmcnt(7)
    v_mfma_f32_16x16x32_bf16 v[112:115], v[128:131], v[48:51], v[112:115]
    ds_read_b128 v[128:131], v5 offset:19456
    s_waitcnt lgkmcnt(7)
    s_waitcnt vmcnt(11)
    buffer_load_dwordx4 v[100:103], v4, s[8:11], s25 offen offset:3072 sc1
    buffer_load_dwordx2 v[200:201], v160, s[8:11], s29 offen sc1
    buffer_load_dwordx4 v[208:211], v1, s[8:11], s30 offen sc1
    buffer_load_dwordx2 v[202:203], v160, s[8:11], s29 offen offset:512 sc1
    buffer_load_dwordx4 v[212:215], v1, s[8:11], s30 offen offset:64 sc1
    buffer_load_dwordx2 v[204:205], v160, s[8:11], s29 offen offset:1024 sc1
    buffer_load_dwordx4 v[216:219], v1, s[8:11], s30 offen offset:128 sc1
    v_mfma_f32_16x16x32_bf16 v[104:107], v[132:135], v[52:55], v[104:107]
    ds_read_b128 v[132:135], v5 offset:20480
    s_waitcnt lgkmcnt(7)
    v_mfma_f32_16x16x32_bf16 v[108:111], v[136:139], v[52:55], v[108:111]
    ds_read_b128 v[136:139], v5 offset:24576
    s_waitcnt lgkmcnt(7)
    v_mfma_f32_16x16x32_bf16 v[112:115], v[140:143], v[52:55], v[112:115]
    ds_read_b128 v[140:143], v5 offset:25600
    s_waitcnt lgkmcnt(7)
    s_waitcnt vmcnt(17)
    v_mfma_f32_16x16x32_bf16 v[104:107], v[144:147], v[56:59], v[104:107]
    ds_read_b128 v[144:147], v5 offset:26624
    s_waitcnt lgkmcnt(7)
    v_mfma_f32_16x16x32_bf16 v[108:111], v[148:151], v[56:59], v[108:111]
    ds_read_b128 v[148:151], v5 offset:30720
    s_waitcnt lgkmcnt(7)
    v_mfma_f32_16x16x32_bf16 v[112:115], v[152:155], v[56:59], v[112:115]
    ds_read_b128 v[152:155], v5 offset:31744
    s_waitcnt lgkmcnt(7)
    s_waitcnt vmcnt(16)
    v_mfma_f32_16x16x32_bf16 v[104:107], v[156:159], v[60:63], v[104:107]
    ds_read_b128 v[156:159], v5 offset:32768
    s_waitcnt lgkmcnt(7)
    v_mfma_f32_16x16x32_bf16 v[108:111], v[128:131], v[60:63], v[108:111]
    ds_read_b128 v[128:131], v5 offset:36864
    s_waitcnt lgkmcnt(7)
    v_mfma_f32_16x16x32_bf16 v[112:115], v[132:135], v[60:63], v[112:115]
    ds_read_b128 v[132:135], v5 offset:37888
    s_waitcnt lgkmcnt(7)
    s_waitcnt vmcnt(15)
    v_mfma_f32_16x16x32_bf16 v[104:107], v[136:139], v[64:67], v[104:107]
    ds_read_b128 v[136:139], v5 offset:38912
    s_waitcnt lgkmcnt(7)
    v_mfma_f32_16x16x32_bf16 v[108:111], v[140:143], v[64:67], v[108:111]
    ds_read_b128 v[140:143], v5 offset:43008
    s_waitcnt lgkmcnt(7)
    v_mfma_f32_16x16x32_bf16 v[112:115], v[144:147], v[64:67], v[112:115]
    ds_read_b128 v[144:147], v5 offset:44032
    s_waitcnt lgkmcnt(7)
    s_waitcnt vmcnt(14)
    v_mfma_f32_16x16x32_bf16 v[104:107], v[148:151], v[68:71], v[104:107]
    ds_read_b128 v[148:151], v5 offset:45056
    s_waitcnt lgkmcnt(7)
    v_mfma_f32_16x16x32_bf16 v[108:111], v[152:155], v[68:71], v[108:111]
    ds_read_b128 v[152:155], v5 offset:49152
    s_waitcnt lgkmcnt(7)
    v_mfma_f32_16x16x32_bf16 v[112:115], v[156:159], v[68:71], v[112:115]
    ds_read_b128 v[156:159], v5 offset:50176
    s_waitcnt lgkmcnt(7)
    s_waitcnt vmcnt(13)
    v_mfma_f32_16x16x32_bf16 v[104:107], v[128:131], v[72:75], v[104:107]
    ds_read_b128 v[128:131], v5 offset:51200
    s_waitcnt lgkmcnt(7)
    v_mfma_f32_16x16x32_bf16 v[108:111], v[132:135], v[72:75], v[108:111]
    ds_read_b128 v[132:135], v5 offset:55296
    s_waitcnt lgkmcnt(7)
    v_mfma_f32_16x16x32_bf16 v[112:115], v[136:139], v[72:75], v[112:115]
    ds_read_b128 v[136:139], v5 offset:56320
    s_waitcnt lgkmcnt(7)
    s_waitcnt vmcnt(12)
    v_mfma_f32_16x16x32_bf16 v[104:107], v[140:143], v[76:79], v[104:107]
    ds_read_b128 v[140:143], v5 offset:57344
    s_waitcnt lgkmcnt(7)
    v_mfma_f32_16x16x32_bf16 v[108:111], v[144:147], v[76:79], v[108:111]
    ds_read_b128 v[144:147], v6 offset:0
    s_waitcnt lgkmcnt(7)
    v_mfma_f32_16x16x32_bf16 v[112:115], v[148:151], v[76:79], v[112:115]
    ds_read_b128 v[148:151], v6 offset:1024
    s_waitcnt lgkmcnt(7)
    s_waitcnt vmcnt(11)
    v_mfma_f32_16x16x32_bf16 v[104:107], v[152:155], v[80:83], v[104:107]
    ds_read_b128 v[152:155], v6 offset:2048
    s_waitcnt lgkmcnt(7)
    v_mfma_f32_16x16x32_bf16 v[108:111], v[156:159], v[80:83], v[108:111]
    ds_read_b128 v[156:159], v6 offset:6144
    s_waitcnt lgkmcnt(7)
    v_mfma_f32_16x16x32_bf16 v[112:115], v[128:131], v[80:83], v[112:115]
    ds_read_b128 v[128:131], v6 offset:7168
    s_waitcnt lgkmcnt(7)
    s_waitcnt vmcnt(10)
    v_mfma_f32_16x16x32_bf16 v[104:107], v[132:135], v[84:87], v[104:107]
    ds_read_b128 v[132:135], v6 offset:8192
    s_waitcnt lgkmcnt(7)
    v_mfma_f32_16x16x32_bf16 v[108:111], v[136:139], v[84:87], v[108:111]
    ds_read_b128 v[136:139], v6 offset:12288
    s_waitcnt lgkmcnt(7)
    v_mfma_f32_16x16x32_bf16 v[112:115], v[140:143], v[84:87], v[112:115]
    ds_read_b128 v[140:143], v6 offset:13312
    s_waitcnt lgkmcnt(7)
    s_waitcnt vmcnt(9)
    v_mfma_f32_16x16x32_bf16 v[104:107], v[144:147], v[88:91], v[104:107]
    ds_read_b128 v[144:147], v6 offset:14336
    s_waitcnt lgkmcnt(7)
    v_mfma_f32_16x16x32_bf16 v[108:111], v[148:151], v[88:91], v[108:111]
    ds_read_b128 v[148:151], v6 offset:18432
    s_waitcnt lgkmcnt(7)
    v_mfma_f32_16x16x32_bf16 v[112:115], v[152:155], v[88:91], v[112:115]
    ds_read_b128 v[152:155], v6 offset:19456
    s_waitcnt lgkmcnt(7)
    s_waitcnt vmcnt(8)
    v_mfma_f32_16x16x32_bf16 v[104:107], v[156:159], v[92:95], v[104:107]
    ds_read_b128 v[156:159], v6 offset:20480
    s_waitcnt lgkmcnt(7)
    v_mfma_f32_16x16x32_bf16 v[108:111], v[128:131], v[92:95], v[108:111]
    s_waitcnt lgkmcnt(6)
    v_mfma_f32_16x16x32_bf16 v[112:115], v[132:135], v[92:95], v[112:115]
    s_waitcnt lgkmcnt(5)
    s_waitcnt vmcnt(7)
    v_mfma_f32_16x16x32_bf16 v[104:107], v[136:139], v[96:99], v[104:107]
    s_waitcnt lgkmcnt(4)
    v_mfma_f32_16x16x32_bf16 v[108:111], v[140:143], v[96:99], v[108:111]
    s_waitcnt lgkmcnt(3)
    v_mfma_f32_16x16x32_bf16 v[112:115], v[144:147], v[96:99], v[112:115]
    s_waitcnt lgkmcnt(2)
    s_waitcnt vmcnt(6)
    v_mfma_f32_16x16x32_bf16 v[104:107], v[148:151], v[100:103], v[104:107]
    s_waitcnt lgkmcnt(1)
    v_mfma_f32_16x16x32_bf16 v[108:111], v[152:155], v[100:103], v[108:111]
    s_waitcnt lgkmcnt(0)
    v_mfma_f32_16x16x32_bf16 v[112:115], v[156:159], v[100:103], v[112:115]
    s_and_b32 s6, s3, 3
    s_mul_i32 s6, s6, 3072
    s_add_u32 s6, s6, 86016
    v_add_u32 v5, s6, v4
    s_cmp_eq_u32 s23, 0
    s_cbranch_scc1 L_standalone__dit_block__diffusion_kernel_lo
    s_nop 4
    ds_write_b128 v5, v[104:107] offset:0
    ds_write_b128 v5, v[108:111] offset:1024
    ds_write_b128 v5, v[112:115] offset:2048
    s_waitcnt lgkmcnt(0)
    s_barrier
    s_endpgm
L_standalone__dit_block__diffusion_kernel_lo:
    v_mul_u32_u24 v6, 768, v2
    v_lshl_add_u32 v6, v3, 3, v6
    s_mul_i32 s31, s56, 12288
    s_mul_i32 s6, s55, 96
    s_add_u32 s31, s31, s6
    s_barrier
    ds_read_b128 v[128:131], v5 offset:0
    ds_read_b128 v[132:135], v5 offset:1024
    ds_read_b128 v[136:139], v5 offset:2048
    s_waitcnt vmcnt(0) lgkmcnt(0)
    v_add_f32 v104, v104, v128
    v_add_f32 v105, v105, v129
    v_add_f32 v106, v106, v130
    v_add_f32 v107, v107, v131
    v_lshlrev_b32 v8, 16, v200
    v_and_b32 v9, 0xffff0000, v200
    v_fma_f32 v8, v104, v208, v8
    v_fma_f32 v9, v105, v209, v9
    v_cvt_pk_bf16_f32 v200, v8, v9
    v_lshlrev_b32 v8, 16, v201
    v_and_b32 v9, 0xffff0000, v201
    v_fma_f32 v8, v106, v210, v8
    v_fma_f32 v9, v107, v211, v9
    v_cvt_pk_bf16_f32 v201, v8, v9
    buffer_store_dwordx2 v[200:201], v6, s[44:47], s31 offen offset:0 sc1
    v_add_f32 v108, v108, v132
    v_add_f32 v109, v109, v133
    v_add_f32 v110, v110, v134
    v_add_f32 v111, v111, v135
    v_lshlrev_b32 v8, 16, v202
    v_and_b32 v9, 0xffff0000, v202
    v_fma_f32 v8, v108, v212, v8
    v_fma_f32 v9, v109, v213, v9
    v_cvt_pk_bf16_f32 v202, v8, v9
    v_lshlrev_b32 v8, 16, v203
    v_and_b32 v9, 0xffff0000, v203
    v_fma_f32 v8, v110, v214, v8
    v_fma_f32 v9, v111, v215, v9
    v_cvt_pk_bf16_f32 v203, v8, v9
    buffer_store_dwordx2 v[202:203], v6, s[44:47], s31 offen offset:32 sc1
    v_add_f32 v112, v112, v136
    v_add_f32 v113, v113, v137
    v_add_f32 v114, v114, v138
    v_add_f32 v115, v115, v139
    v_lshlrev_b32 v8, 16, v204
    v_and_b32 v9, 0xffff0000, v204
    v_fma_f32 v8, v112, v216, v8
    v_fma_f32 v9, v113, v217, v9
    v_cvt_pk_bf16_f32 v204, v8, v9
    v_lshlrev_b32 v8, 16, v205
    v_and_b32 v9, 0xffff0000, v205
    v_fma_f32 v8, v114, v218, v8
    v_fma_f32 v9, v115, v219, v9
    v_cvt_pk_bf16_f32 v205, v8, v9
    buffer_store_dwordx2 v[204:205], v6, s[44:47], s31 offen offset:64 sc1
L_standalone__dit_block__diffusion_kernel_end:
    s_endpgm
.section .rodata,"a"
.p2align 6
.amdhsa_kernel standalone__dit_block__diffusion_kernel
  .amdhsa_next_free_vgpr 256
  .amdhsa_next_free_sgpr 102
  .amdhsa_accum_offset 256
  .amdhsa_group_segment_fixed_size 0
  .amdhsa_kernarg_size 80
  .amdhsa_user_sgpr_count 2
  .amdhsa_user_sgpr_kernarg_segment_ptr 1
  .amdhsa_system_sgpr_workgroup_id_x 1
.end_amdhsa_kernel
```
